```python
import torch

def _softmax(x, axis=-1):
    return torch.softmax(x, dim=axis)

def _gelu(x):
    return torch.nn.functional.gelu(x, approximate='tanh')

def _silu(x):
    return torch.nn.functional.silu(x)

def _sigmoid(x):
    return torch.sigmoid(x)

def _layernorm(x, axis=-1, eps=1e-05):
    m = x.mean(dim=axis, keepdim=True)
    v = x.var(dim=axis, keepdim=True, unbiased=False)
    return (x - m) / torch.sqrt(v + eps)

def _scatter_add(tgt, idx, src, axis=0):
    return tgt.clone().index_add_(axis, idx, src)

def _segment_sum(src, seg, n):
    out = torch.zeros((n,) + src.shape[1:], dtype=src.dtype)
    return out.index_add_(0, seg, src)

def _pad(x, pw):
    flat = tuple((v for pair in reversed(pw) for v in pair))
    return torch.nn.functional.pad(x, flat)
kernel_name = 'adaLN_cond__sliding_local_dilated__dense_activation_silu__prompt'

def setup_inputs():

    _w = lambda a: (lambda t: t.to(torch.bfloat16) if t.is_floating_point() else t)(torch.as_tensor(a))

    def _A_setup():
        B, S, D = (1, 2048, 448)
        return {'x': _w((lambda *s: torch.randn(*s, dtype=torch.bfloat16) * 0.05)(B, S, D)), 'wqkv': _w((lambda *s: torch.randn(*s, dtype=torch.bfloat16) * 0.05)(D, 3 * D)), 'wo': _w((lambda *s: torch.randn(*s, dtype=torch.bfloat16) * 0.05)(D, D))}
    _A_in = _A_setup()

    def _B_setup():
        B, S, D, F = (1, 2048, 448, 1792)
        return {'x': _w((lambda *s: torch.randn(*s, dtype=torch.bfloat16) * 0.05)(B, S, D)), 'w1': _w((lambda *s: torch.randn(*s, dtype=torch.bfloat16) * 3.2)(D, F) * D ** (-0.5)), 'w2': _w((lambda *s: torch.randn(*s, dtype=torch.bfloat16) * 0.4)(F, D) * F ** (-0.5))}
    _B_in = _B_setup()
    return {'A_x': _A_in['x'], 'A_wqkv': _A_in['wqkv'], 'A_wo': _A_in['wo'], 'B_x': _B_in['x'], 'B_w1': _B_in['w1'], 'B_w2': _B_in['w2'], 'c': _w((lambda *s: torch.randn(*s, dtype=torch.bfloat16) * 0.1)(1, 448) * 8.0), 'w_mod': _w((lambda *s: torch.randn(*s, dtype=torch.bfloat16) * 0.1)(448, 6 * 448) * 448 ** (-0.5) * 8.0)}

def reference(A_x, A_wqkv, A_wo, B_x, B_w1, B_w2, c, w_mod):

    def _A_ref(x, wqkv, wo):
        B, S, D = x.shape
        H = 16
        Dh = D // H
        W, dil = (8, 2)
        qkv = (lambda x, *d: x.permute(*d))((x @ wqkv).reshape(B, S, 3, H, Dh), 2, 0, 3, 1, 4)
        q, k, v = (qkv[0], qkv[1], qkv[2])
        scale = Dh ** (-0.5)
        pos = torch.arange(S)
        off = torch.arange(W) * dil
        idx = pos[:, None] - off[None, :]
        mask = idx >= 0
        idx_c = torch.where(mask, idx, 0).reshape(-1)
        kg = k[:, :, idx_c, :].reshape(B, H, S, W, Dh)
        vg = v[:, :, idx_c, :].reshape(B, H, S, W, Dh)
        logits = torch.einsum('bhsd,bhswd->bhsw', q, kg) * scale
        logits = torch.where(mask[None, None, :, :], logits, -1000000000.0)
        attn = _softmax(logits, axis=-1)
        o = torch.einsum('bhsw,bhswd->bhsd', attn, vg)
        return (lambda x, *d: x.permute(*d))(o, 0, 2, 1, 3).reshape(B, S, D) @ wo

    def _B_ref(x, w1, w2):
        h = torch.einsum('bsd,df->bsf', x, w1)
        h = _silu(h)
        out = torch.einsum('bsf,fd->bsd', h, w2)
        return out
    x = A_x
    mod = (_silu(c) @ w_mod).reshape(c.shape[0], 6, 1, -1)
    sa, ca, ga, sb, cb, gb = (mod[:, 0].clone(), mod[:, 1].clone(), mod[:, 2].clone(), mod[:, 3].clone(), mod[:, 4].clone(), mod[:, 5].clone())
    h = _layernorm(x, axis=-1) * (1 + ca) + sa
    x = x + ga * _A_ref(h, A_wqkv, A_wo)
    h = _layernorm(x, axis=-1) * (1 + cb) + sb
    x = x + gb * _B_ref(h, B_w1, B_w2)
    return x
```

```asm
; @launch grid=(256,1,1) block=(512,1,1) lds=163840
.amdgcn_target "amdgcn-amd-amdhsa--gfx950"
.text
.globl adaLN_cond__sliding_local_dilated__dense_activation_silu__prompt_kernel
.p2align 8
.type adaLN_cond__sliding_local_dilated__dense_activation_silu__prompt_kernel,@function
adaLN_cond__sliding_local_dilated__dense_activation_silu__prompt_kernel:
    s_cmp_ge_u32 s2, 0x100
    s_cbranch_scc1 L_end
    s_getpc_b64 s[96:97]
    s_load_dwordx16 s[4:19], s[0:1], 0
    s_load_dwordx4 s[20:23], s[0:1], 64
    s_load_dwordx2 s[24:25], s[0:1], 0x50
    v_and_b32 v1, 63, v0
    v_lshrrev_b32 v10, 6, v0
    v_and_b32 v2, 15, v1
    v_lshrrev_b32 v3, 4, v1
    v_lshlrev_b32 v4, 4, v1
    v_readfirstlane_b32 s70, v10
    v_mul_u32_u24 v5, 0x3a0, v2
    v_lshl_add_u32 v5, v3, 4, v5
    v_and_b32 v10, 1, v3
    v_lshrrev_b32 v9, 1, v3
    v_lshl_add_u32 v9, v10, 1, v9
    s_and_b32 s72, s2, 7
    s_lshr_b32 s73, s2, 3
    s_and_b32 s69, s73, 7
    s_lshr_b32 s73, s73, 3
    s_lshl_b32 s68, s72, 2
    s_add_u32 s68, s68, s73
    s_lshl_b32 s100, s68, 6
    s_and_b32 s3, s68, 3
    s_and_b32 s89, s69, 1
    s_lshl_b32 s89, s89, 2
    s_xor_b32 s89, s89, s70
    s_mov_b32 s90, -1
    s_mov_b32 s91, 0xffffff
    s_mul_i32 s80, s70, 0x2800
    s_add_u32 s80, s80, 0x10000
    s_cmp_lg_u32 s70, 1
    s_cbranch_scc1 L_nocpf
    s_lshr_b32 s72, s2, 3
    s_lshl_b32 s72, s72, 11
    v_lshlrev_b32 v11, 7, v2
    v_add_u32 v11, s72, v11
    v_min_u32 v11, CODE_BYTES, v11
    global_load_dword v242, v11, s[96:97]
L_nocpf:
    v_mov_b32 v8, 0x27200
    v_bfe_u32 v11, v1, 2, 2
    v_and_b32 v12, 3, v1
    v_lshlrev_b32 v11, 6, v11
    v_lshl_add_u32 v11, v12, 3, v11
    v_lshl_add_u32 v11, v10, 5, v11
    v_lshl_add_u32 v12, v3, 9, v11
    v_lshl_add_u32 v13, v3, 8, v11
    v_add_u32 v134, s80, v12
    v_xor_b32 v135, 32, v134
    v_add_u32 v132, s80, v13
    v_xor_b32 v133, 32, v132
    s_and_b32 s72, s70, 3
    s_lshr_b32 s73, s70, 2
    s_mul_i32 s82, s72, 0x5400
    s_mul_i32 s74, s69, 0x70
    s_add_u32 s82, s82, s74
    s_mul_i32 s74, s73, 0x7e000
    s_add_u32 s82, s82, s74
    s_lshl_b32 s81, s72, 10
    s_and_b32 s74, s72, 1
    s_lshl_b32 s74, s74, 2
    v_lshrrev_b32 v14, 3, v1
    v_and_b32 v15, 2, v14
    v_or_b32 v15, s74, v15
    v_xor_b32 v15, v15, v1
    v_and_b32 v15, 7, v15
    v_min_u32 v15, 6, v15
    v_mul_u32_u24 v254, 0xa80, v14
    v_lshl_add_u32 v254, v15, 4, v254
    s_lshr_b32 s72, s70, 1
    s_and_b32 s72, s72, 1
    s_mul_i32 s72, s72, 56
    s_and_b32 s74, s70, 1
    s_add_u32 s74, s74, 1
    s_cmp_lt_u32 s70, 4
    s_cselect_b32 s74, s74, 0
    s_lshl_b32 s74, s74, 12
    v_bfe_u32 v14, v1, 2, 2
    v_lshlrev_b32 v15, 10, v3
    v_lshl_add_u32 v15, v14, 7, v15
    v_add_u32 v15, s74, v15
    v_and_b32 v14, 2, v14
    v_lshl_or_b32 v14, v10, 2, v14
    v_lshlrev_b32 v14, 4, v14
    v_and_b32 v16, 3, v1
    v_lshlrev_b32 v16, 3, v16
    v_add_u32 v16, s72, v16
    v_xor_b32 v17, v16, v14
    v_add_u32 v250, v15, v17
    v_add_u32 v252, 0x12200, v250
    v_add_u32 v16, 32, v16
    v_xor_b32 v17, v16, v14
    v_add_u32 v251, v15, v17
    v_add_u32 v253, 0x12200, v251
    s_mul_i32 s72, s70, 0xe000
    s_lshl_b32 s73, s69, 7
    s_add_u32 s83, s72, s73
    s_lshl_b32 s72, s69, 9
    s_lshr_b32 s74, s70, 1
    s_lshl_b32 s74, s74, 7
    s_add_u32 s84, s72, s74
    s_and_b32 s74, s70, 1
    s_mul_i32 s74, s74, 0xc4000
    s_add_u32 s84, s84, s74
    s_mul_i32 s72, s70, 0x7000
    s_add_u32 s85, s72, s73
    s_mov_b32 s87, 0
    s_min_u32 s88, s69, 6
    s_mul_i32 s72, s88, 0x38000
    s_add_u32 s85, s85, s72
    s_lshl_b32 s88, s88, 1
    s_waitcnt lgkmcnt(0)
    s_mov_b32 s28, s4
    s_and_b32 s29, s5, 0xffff
    s_mov_b32 s30, 0x1c0000
    s_mov_b32 s31, 0x20000
    s_mov_b32 s32, s6
    s_and_b32 s33, s7, 0xffff
    s_mov_b32 s34, 0x126000
    s_mov_b32 s35, 0x20000
    s_mov_b32 s36, s8
    s_and_b32 s37, s9, 0xffff
    s_mov_b32 s38, 0x62000
    s_mov_b32 s39, 0x20000
    s_mov_b32 s40, s12
    s_and_b32 s41, s13, 0xffff
    s_mov_b32 s42, 0x188000
    s_mov_b32 s43, 0x20000
    s_mov_b32 s44, s14
    s_and_b32 s45, s15, 0xffff
    s_mov_b32 s46, 0x188000
    s_mov_b32 s47, 0x20000
    s_mov_b32 s48, s16
    s_and_b32 s49, s17, 0xffff
    s_mov_b32 s50, 0x380
    s_mov_b32 s51, 0x20000
    s_mov_b32 s52, s18
    s_and_b32 s53, s19, 0xffff
    s_mov_b32 s54, 0x24c000
    s_mov_b32 s55, 0x20000
    s_mov_b32 s56, s20
    s_and_b32 s57, s21, 0xffff
    s_mov_b32 s58, 0x1c0000
    s_mov_b32 s59, 0x20000
    s_mov_b32 s60, s24
    s_and_b32 s61, s25, 0xffff
    s_mov_b32 s62, 0x1000000
    s_mov_b32 s63, 0x20000
    s_mov_b32 s64, s22
    s_and_b32 s65, s23, 0xffff
    s_mov_b32 s66, 0x100
    s_mov_b32 s67, 0x20000
    s_cmp_lg_u32 s70, 0
    s_cbranch_scc1 L_nonce_pub
    s_cmp_lg_u32 s2, 0
    s_cbranch_scc1 L_nonce_pub
    v_mov_b32 v10, 0
    s_memrealtime s[26:27]
    s_waitcnt lgkmcnt(0)
    s_or_b32 s71, s26, 1
    v_mov_b32 v11, s71
    s_mov_b64 exec, 1
    buffer_store_dword v11, v10, s[64:67], 0 offen sc1
    s_mov_b64 exec, -1
L_nonce_pub:
    s_cmp_eq_u32 s69, 7
    s_cselect_b32 s78, s68, -1
    s_cmp_ge_u32 s78, 21
    s_cselect_b32 s78, -1, s78
    s_cmp_lg_u32 s70, 1
    s_cbranch_scc1 L_ntm
    v_lshrrev_b32 v249, 5, v1
    v_mul_u32_u24 v249, 0x1500, v249
    v_and_b32 v248, 31, v1
    v_min_u32 v248, 20, v248
    v_lshl_add_u32 v249, v248, 7, v249
    s_mul_i32 s72, s2, 0x2a00
    buffer_load_dword v248, v249, s[52:55], s72 offen
L_ntm:
    s_cmp_lg_u32 s70, 0
    s_cbranch_scc1 ntch_1
    s_mul_i32 s72, s2, 0x1280
    v_min_u32 v249, 36, v1
    v_lshlrev_b32 v249, 7, v249
    buffer_load_dword v248, v249, s[32:35], s72 offen
ntch_1:
    v_lshlrev_b32 v10, 2, v1
    v_add_u32 v10, 0x27200, v10
    v_mov_b32 v11, 0
    ds_write_b32 v10, v11
    s_waitcnt lgkmcnt(0)
    s_barrier
    s_cmp_eq_u32 s78, -1
    s_cbranch_scc1 L_nomod
    s_cmp_lt_u32 s70, 4
    s_cbranch_scc1 L_mod1
    s_barrier
    s_branch L_nomod
L_mod1:
    v_lshrrev_b32 v10, 3, v1
    v_mul_u32_u24 v10, 14, v10
    s_mul_i32 s72, s70, 0x70
    v_add_u32 v10, s72, v10
    v_lshlrev_b32 v11, 1, v10
    v_mul_u32_u24 v10, 0x1500, v10
    v_and_b32 v12, 7, v1
    v_lshl_add_u32 v10, v12, 4, v10
    v_mov_b32 v112, 0
    buffer_load_dword v112, v112, s[64:67], 0 offen sc1
    buffer_load_dwordx4 v[100:103], v11, s[48:51], 0 offen
    buffer_load_dwordx4 v[104:107], v11, s[48:51], 0 offen offset:16
    s_lshl_b32 s72, s68, 7
    buffer_load_dwordx4 v[20:23], v10, s[52:55], s72 offen
    s_add_u32 s72, s72, 0x1500
    buffer_load_dwordx4 v[24:27], v10, s[52:55], s72 offen
    s_add_u32 s72, s72, 0x1500
    buffer_load_dwordx4 v[28:31], v10, s[52:55], s72 offen
    s_add_u32 s72, s72, 0x1500
    buffer_load_dwordx4 v[32:35], v10, s[52:55], s72 offen
    s_add_u32 s72, s72, 0x1500
    buffer_load_dwordx4 v[36:39], v10, s[52:55], s72 offen
    s_add_u32 s72, s72, 0x1500
    buffer_load_dwordx4 v[40:43], v10, s[52:55], s72 offen
    s_add_u32 s72, s72, 0x1500
    buffer_load_dwordx4 v[44:47], v10, s[52:55], s72 offen
    s_add_u32 s72, s72, 0x1500
    buffer_load_dwordx4 v[48:51], v10, s[52:55], s72 offen
    s_add_u32 s72, s72, 0x1500
    buffer_load_dwordx4 v[52:55], v10, s[52:55], s72 offen
    s_add_u32 s72, s72, 0x1500
    buffer_load_dwordx4 v[56:59], v10, s[52:55], s72 offen
    s_add_u32 s72, s72, 0x1500
    buffer_load_dwordx4 v[60:63], v10, s[52:55], s72 offen
    s_add_u32 s72, s72, 0x1500
    buffer_load_dwordx4 v[64:67], v10, s[52:55], s72 offen
    s_add_u32 s72, s72, 0x1500
    buffer_load_dwordx4 v[68:71], v10, s[52:55], s72 offen
    s_add_u32 s72, s72, 0x1500
    buffer_load_dwordx4 v[72:75], v10, s[52:55], s72 offen
    s_barrier
    s_waitcnt vmcnt(14)
    v_lshlrev_b32 v76, 16, v100
    v_and_b32 v77, 0xffff0000, v100
    v_lshlrev_b32 v78, 16, v101
    v_and_b32 v79, 0xffff0000, v101
    v_lshlrev_b32 v80, 16, v102
    v_and_b32 v81, 0xffff0000, v102
    v_lshlrev_b32 v82, 16, v103
    v_and_b32 v83, 0xffff0000, v103
    v_lshlrev_b32 v84, 16, v104
    v_and_b32 v85, 0xffff0000, v104
    v_lshlrev_b32 v86, 16, v105
    v_and_b32 v87, 0xffff0000, v105
    v_lshlrev_b32 v88, 16, v106
    v_and_b32 v89, 0xffff0000, v106
    v_mul_f32 v10, 0xbfb8aa3b, v76
    v_mul_f32 v11, 0xbfb8aa3b, v77
    v_mul_f32 v12, 0xbfb8aa3b, v78
    v_mul_f32 v13, 0xbfb8aa3b, v79
    v_mul_f32 v14, 0xbfb8aa3b, v80
    v_mul_f32 v15, 0xbfb8aa3b, v81
    v_mul_f32 v16, 0xbfb8aa3b, v82
    v_mul_f32 v17, 0xbfb8aa3b, v83
    v_exp_f32 v10, v10
    v_exp_f32 v11, v11
    v_exp_f32 v12, v12
    v_exp_f32 v13, v13
    v_exp_f32 v14, v14
    v_exp_f32 v15, v15
    v_exp_f32 v16, v16
    v_exp_f32 v17, v17
    v_add_f32 v10, 1.0, v10
    v_add_f32 v11, 1.0, v11
    v_add_f32 v12, 1.0, v12
    v_add_f32 v13, 1.0, v13
    v_add_f32 v14, 1.0, v14
    v_add_f32 v15, 1.0, v15
    v_add_f32 v16, 1.0, v16
    v_add_f32 v17, 1.0, v17
    v_rcp_f32 v10, v10
    v_rcp_f32 v11, v11
    v_rcp_f32 v12, v12
    v_rcp_f32 v13, v13
    v_rcp_f32 v14, v14
    v_rcp_f32 v15, v15
    v_rcp_f32 v16, v16
    v_rcp_f32 v17, v17
    v_mul_f32 v76, v76, v10
    v_mul_f32 v77, v77, v11
    v_mul_f32 v78, v78, v12
    v_mul_f32 v79, v79, v13
    v_mul_f32 v80, v80, v14
    v_mul_f32 v81, v81, v15
    v_mul_f32 v82, v82, v16
    v_mul_f32 v83, v83, v17
    v_mul_f32 v10, 0xbfb8aa3b, v84
    v_mul_f32 v11, 0xbfb8aa3b, v85
    v_mul_f32 v12, 0xbfb8aa3b, v86
    v_mul_f32 v13, 0xbfb8aa3b, v87
    v_mul_f32 v14, 0xbfb8aa3b, v88
    v_mul_f32 v15, 0xbfb8aa3b, v89
    v_exp_f32 v10, v10
    v_exp_f32 v11, v11
    v_exp_f32 v12, v12
    v_exp_f32 v13, v13
    v_exp_f32 v14, v14
    v_exp_f32 v15, v15
    v_add_f32 v10, 1.0, v10
    v_add_f32 v11, 1.0, v11
    v_add_f32 v12, 1.0, v12
    v_add_f32 v13, 1.0, v13
    v_add_f32 v14, 1.0, v14
    v_add_f32 v15, 1.0, v15
    v_rcp_f32 v10, v10
    v_rcp_f32 v11, v11
    v_rcp_f32 v12, v12
    v_rcp_f32 v13, v13
    v_rcp_f32 v14, v14
    v_rcp_f32 v15, v15
    v_mul_f32 v84, v84, v10
    v_mul_f32 v85, v85, v11
    v_mul_f32 v86, v86, v12
    v_mul_f32 v87, v87, v13
    v_mul_f32 v88, v88, v14
    v_mul_f32 v89, v89, v15
    v_cvt_pk_bf16_f32 v10, v76, v77
    v_lshlrev_b32 v76, 16, v10
    v_and_b32 v77, 0xffff0000, v10
    v_cvt_pk_bf16_f32 v11, v78, v79
    v_lshlrev_b32 v78, 16, v11
    v_and_b32 v79, 0xffff0000, v11
    v_cvt_pk_bf16_f32 v12, v80, v81
    v_lshlrev_b32 v80, 16, v12
    v_and_b32 v81, 0xffff0000, v12
    v_cvt_pk_bf16_f32 v13, v82, v83
    v_lshlrev_b32 v82, 16, v13
    v_and_b32 v83, 0xffff0000, v13
    v_cvt_pk_bf16_f32 v14, v84, v85
    v_lshlrev_b32 v84, 16, v14
    v_and_b32 v85, 0xffff0000, v14
    v_cvt_pk_bf16_f32 v15, v86, v87
    v_lshlrev_b32 v86, 16, v15
    v_and_b32 v87, 0xffff0000, v15
    v_cvt_pk_bf16_f32 v16, v88, v89
    v_lshlrev_b32 v88, 16, v16
    v_and_b32 v89, 0xffff0000, v16
    s_waitcnt vmcnt(13)
    v_lshlrev_b32 v108, 16, v20
    v_and_b32 v109, 0xffff0000, v20
    v_pk_mul_f32 v[92:93], v[108:109], v[76:77] op_sel:[0,0] op_sel_hi:[1,0]
    v_lshlrev_b32 v110, 16, v21
    v_and_b32 v111, 0xffff0000, v21
    v_pk_mul_f32 v[94:95], v[110:111], v[76:77] op_sel:[0,0] op_sel_hi:[1,0]
    v_lshlrev_b32 v108, 16, v22
    v_and_b32 v109, 0xffff0000, v22
    v_pk_mul_f32 v[96:97], v[108:109], v[76:77] op_sel:[0,0] op_sel_hi:[1,0]
    v_lshlrev_b32 v110, 16, v23
    v_and_b32 v111, 0xffff0000, v23
    v_pk_mul_f32 v[98:99], v[110:111], v[76:77] op_sel:[0,0] op_sel_hi:[1,0]
    s_waitcnt vmcnt(12)
    v_lshlrev_b32 v108, 16, v24
    v_and_b32 v109, 0xffff0000, v24
    v_pk_fma_f32 v[92:93], v[108:109], v[76:77], v[92:93] op_sel:[0,1,0] op_sel_hi:[1,1,1]
    v_lshlrev_b32 v110, 16, v25
    v_and_b32 v111, 0xffff0000, v25
    v_pk_fma_f32 v[94:95], v[110:111], v[76:77], v[94:95] op_sel:[0,1,0] op_sel_hi:[1,1,1]
    v_lshlrev_b32 v108, 16, v26
    v_and_b32 v109, 0xffff0000, v26
    v_pk_fma_f32 v[96:97], v[108:109], v[76:77], v[96:97] op_sel:[0,1,0] op_sel_hi:[1,1,1]
    v_lshlrev_b32 v110, 16, v27
    v_and_b32 v111, 0xffff0000, v27
    v_pk_fma_f32 v[98:99], v[110:111], v[76:77], v[98:99] op_sel:[0,1,0] op_sel_hi:[1,1,1]
    s_waitcnt vmcnt(11)
    v_lshlrev_b32 v108, 16, v28
    v_and_b32 v109, 0xffff0000, v28
    v_pk_fma_f32 v[92:93], v[108:109], v[78:79], v[92:93] op_sel:[0,0,0] op_sel_hi:[1,0,1]
    v_lshlrev_b32 v110, 16, v29
    v_and_b32 v111, 0xffff0000, v29
    v_pk_fma_f32 v[94:95], v[110:111], v[78:79], v[94:95] op_sel:[0,0,0] op_sel_hi:[1,0,1]
    v_lshlrev_b32 v108, 16, v30
    v_and_b32 v109, 0xffff0000, v30
    v_pk_fma_f32 v[96:97], v[108:109], v[78:79], v[96:97] op_sel:[0,0,0] op_sel_hi:[1,0,1]
    v_lshlrev_b32 v110, 16, v31
    v_and_b32 v111, 0xffff0000, v31
    v_pk_fma_f32 v[98:99], v[110:111], v[78:79], v[98:99] op_sel:[0,0,0] op_sel_hi:[1,0,1]
    s_waitcnt vmcnt(10)
    v_lshlrev_b32 v108, 16, v32
    v_and_b32 v109, 0xffff0000, v32
    v_pk_fma_f32 v[92:93], v[108:109], v[78:79], v[92:93] op_sel:[0,1,0] op_sel_hi:[1,1,1]
    v_lshlrev_b32 v110, 16, v33
    v_and_b32 v111, 0xffff0000, v33
    v_pk_fma_f32 v[94:95], v[110:111], v[78:79], v[94:95] op_sel:[0,1,0] op_sel_hi:[1,1,1]
    v_lshlrev_b32 v108, 16, v34
    v_and_b32 v109, 0xffff0000, v34
    v_pk_fma_f32 v[96:97], v[108:109], v[78:79], v[96:97] op_sel:[0,1,0] op_sel_hi:[1,1,1]
    v_lshlrev_b32 v110, 16, v35
    v_and_b32 v111, 0xffff0000, v35
    v_pk_fma_f32 v[98:99], v[110:111], v[78:79], v[98:99] op_sel:[0,1,0] op_sel_hi:[1,1,1]
    s_waitcnt vmcnt(9)
    v_lshlrev_b32 v108, 16, v36
    v_and_b32 v109, 0xffff0000, v36
    v_pk_fma_f32 v[92:93], v[108:109], v[80:81], v[92:93] op_sel:[0,0,0] op_sel_hi:[1,0,1]
    v_lshlrev_b32 v110, 16, v37
    v_and_b32 v111, 0xffff0000, v37
    v_pk_fma_f32 v[94:95], v[110:111], v[80:81], v[94:95] op_sel:[0,0,0] op_sel_hi:[1,0,1]
    v_lshlrev_b32 v108, 16, v38
    v_and_b32 v109, 0xffff0000, v38
    v_pk_fma_f32 v[96:97], v[108:109], v[80:81], v[96:97] op_sel:[0,0,0] op_sel_hi:[1,0,1]
    v_lshlrev_b32 v110, 16, v39
    v_and_b32 v111, 0xffff0000, v39
    v_pk_fma_f32 v[98:99], v[110:111], v[80:81], v[98:99] op_sel:[0,0,0] op_sel_hi:[1,0,1]
    s_waitcnt vmcnt(8)
    v_lshlrev_b32 v108, 16, v40
    v_and_b32 v109, 0xffff0000, v40
    v_pk_fma_f32 v[92:93], v[108:109], v[80:81], v[92:93] op_sel:[0,1,0] op_sel_hi:[1,1,1]
    v_lshlrev_b32 v110, 16, v41
    v_and_b32 v111, 0xffff0000, v41
    v_pk_fma_f32 v[94:95], v[110:111], v[80:81], v[94:95] op_sel:[0,1,0] op_sel_hi:[1,1,1]
    v_lshlrev_b32 v108, 16, v42
    v_and_b32 v109, 0xffff0000, v42
    v_pk_fma_f32 v[96:97], v[108:109], v[80:81], v[96:97] op_sel:[0,1,0] op_sel_hi:[1,1,1]
    v_lshlrev_b32 v110, 16, v43
    v_and_b32 v111, 0xffff0000, v43
    v_pk_fma_f32 v[98:99], v[110:111], v[80:81], v[98:99] op_sel:[0,1,0] op_sel_hi:[1,1,1]
    s_waitcnt vmcnt(7)
    v_lshlrev_b32 v108, 16, v44
    v_and_b32 v109, 0xffff0000, v44
    v_pk_fma_f32 v[92:93], v[108:109], v[82:83], v[92:93] op_sel:[0,0,0] op_sel_hi:[1,0,1]
    v_lshlrev_b32 v110, 16, v45
    v_and_b32 v111, 0xffff0000, v45
    v_pk_fma_f32 v[94:95], v[110:111], v[82:83], v[94:95] op_sel:[0,0,0] op_sel_hi:[1,0,1]
    v_lshlrev_b32 v108, 16, v46
    v_and_b32 v109, 0xffff0000, v46
    v_pk_fma_f32 v[96:97], v[108:109], v[82:83], v[96:97] op_sel:[0,0,0] op_sel_hi:[1,0,1]
    v_lshlrev_b32 v110, 16, v47
    v_and_b32 v111, 0xffff0000, v47
    v_pk_fma_f32 v[98:99], v[110:111], v[82:83], v[98:99] op_sel:[0,0,0] op_sel_hi:[1,0,1]
    s_waitcnt vmcnt(6)
    v_lshlrev_b32 v108, 16, v48
    v_and_b32 v109, 0xffff0000, v48
    v_pk_fma_f32 v[92:93], v[108:109], v[82:83], v[92:93] op_sel:[0,1,0] op_sel_hi:[1,1,1]
    v_lshlrev_b32 v110, 16, v49
    v_and_b32 v111, 0xffff0000, v49
    v_pk_fma_f32 v[94:95], v[110:111], v[82:83], v[94:95] op_sel:[0,1,0] op_sel_hi:[1,1,1]
    v_lshlrev_b32 v108, 16, v50
    v_and_b32 v109, 0xffff0000, v50
    v_pk_fma_f32 v[96:97], v[108:109], v[82:83], v[96:97] op_sel:[0,1,0] op_sel_hi:[1,1,1]
    v_lshlrev_b32 v110, 16, v51
    v_and_b32 v111, 0xffff0000, v51
    v_pk_fma_f32 v[98:99], v[110:111], v[82:83], v[98:99] op_sel:[0,1,0] op_sel_hi:[1,1,1]
    s_waitcnt vmcnt(5)
    v_lshlrev_b32 v108, 16, v52
    v_and_b32 v109, 0xffff0000, v52
    v_pk_fma_f32 v[92:93], v[108:109], v[84:85], v[92:93] op_sel:[0,0,0] op_sel_hi:[1,0,1]
    v_lshlrev_b32 v110, 16, v53
    v_and_b32 v111, 0xffff0000, v53
    v_pk_fma_f32 v[94:95], v[110:111], v[84:85], v[94:95] op_sel:[0,0,0] op_sel_hi:[1,0,1]
    v_lshlrev_b32 v108, 16, v54
    v_and_b32 v109, 0xffff0000, v54
    v_pk_fma_f32 v[96:97], v[108:109], v[84:85], v[96:97] op_sel:[0,0,0] op_sel_hi:[1,0,1]
    v_lshlrev_b32 v110, 16, v55
    v_and_b32 v111, 0xffff0000, v55
    v_pk_fma_f32 v[98:99], v[110:111], v[84:85], v[98:99] op_sel:[0,0,0] op_sel_hi:[1,0,1]
    s_waitcnt vmcnt(4)
    v_lshlrev_b32 v108, 16, v56
    v_and_b32 v109, 0xffff0000, v56
    v_pk_fma_f32 v[92:93], v[108:109], v[84:85], v[92:93] op_sel:[0,1,0] op_sel_hi:[1,1,1]
    v_lshlrev_b32 v110, 16, v57
    v_and_b32 v111, 0xffff0000, v57
    v_pk_fma_f32 v[94:95], v[110:111], v[84:85], v[94:95] op_sel:[0,1,0] op_sel_hi:[1,1,1]
    v_lshlrev_b32 v108, 16, v58
    v_and_b32 v109, 0xffff0000, v58
    v_pk_fma_f32 v[96:97], v[108:109], v[84:85], v[96:97] op_sel:[0,1,0] op_sel_hi:[1,1,1]
    v_lshlrev_b32 v110, 16, v59
    v_and_b32 v111, 0xffff0000, v59
    v_pk_fma_f32 v[98:99], v[110:111], v[84:85], v[98:99] op_sel:[0,1,0] op_sel_hi:[1,1,1]
    s_waitcnt vmcnt(3)
    v_lshlrev_b32 v108, 16, v60
    v_and_b32 v109, 0xffff0000, v60
    v_pk_fma_f32 v[92:93], v[108:109], v[86:87], v[92:93] op_sel:[0,0,0] op_sel_hi:[1,0,1]
    v_lshlrev_b32 v110, 16, v61
    v_and_b32 v111, 0xffff0000, v61
    v_pk_fma_f32 v[94:95], v[110:111], v[86:87], v[94:95] op_sel:[0,0,0] op_sel_hi:[1,0,1]
    v_lshlrev_b32 v108, 16, v62
    v_and_b32 v109, 0xffff0000, v62
    v_pk_fma_f32 v[96:97], v[108:109], v[86:87], v[96:97] op_sel:[0,0,0] op_sel_hi:[1,0,1]
    v_lshlrev_b32 v110, 16, v63
    v_and_b32 v111, 0xffff0000, v63
    v_pk_fma_f32 v[98:99], v[110:111], v[86:87], v[98:99] op_sel:[0,0,0] op_sel_hi:[1,0,1]
    s_waitcnt vmcnt(2)
    v_lshlrev_b32 v108, 16, v64
    v_and_b32 v109, 0xffff0000, v64
    v_pk_fma_f32 v[92:93], v[108:109], v[86:87], v[92:93] op_sel:[0,1,0] op_sel_hi:[1,1,1]
    v_lshlrev_b32 v110, 16, v65
    v_and_b32 v111, 0xffff0000, v65
    v_pk_fma_f32 v[94:95], v[110:111], v[86:87], v[94:95] op_sel:[0,1,0] op_sel_hi:[1,1,1]
    v_lshlrev_b32 v108, 16, v66
    v_and_b32 v109, 0xffff0000, v66
    v_pk_fma_f32 v[96:97], v[108:109], v[86:87], v[96:97] op_sel:[0,1,0] op_sel_hi:[1,1,1]
    v_lshlrev_b32 v110, 16, v67
    v_and_b32 v111, 0xffff0000, v67
    v_pk_fma_f32 v[98:99], v[110:111], v[86:87], v[98:99] op_sel:[0,1,0] op_sel_hi:[1,1,1]
    s_waitcnt vmcnt(1)
    v_lshlrev_b32 v108, 16, v68
    v_and_b32 v109, 0xffff0000, v68
    v_pk_fma_f32 v[92:93], v[108:109], v[88:89], v[92:93] op_sel:[0,0,0] op_sel_hi:[1,0,1]
    v_lshlrev_b32 v110, 16, v69
    v_and_b32 v111, 0xffff0000, v69
    v_pk_fma_f32 v[94:95], v[110:111], v[88:89], v[94:95] op_sel:[0,0,0] op_sel_hi:[1,0,1]
    v_lshlrev_b32 v108, 16, v70
    v_and_b32 v109, 0xffff0000, v70
    v_pk_fma_f32 v[96:97], v[108:109], v[88:89], v[96:97] op_sel:[0,0,0] op_sel_hi:[1,0,1]
    v_lshlrev_b32 v110, 16, v71
    v_and_b32 v111, 0xffff0000, v71
    v_pk_fma_f32 v[98:99], v[110:111], v[88:89], v[98:99] op_sel:[0,0,0] op_sel_hi:[1,0,1]
    s_waitcnt vmcnt(0)
    v_lshlrev_b32 v108, 16, v72
    v_and_b32 v109, 0xffff0000, v72
    v_pk_fma_f32 v[92:93], v[108:109], v[88:89], v[92:93] op_sel:[0,1,0] op_sel_hi:[1,1,1]
    v_lshlrev_b32 v110, 16, v73
    v_and_b32 v111, 0xffff0000, v73
    v_pk_fma_f32 v[94:95], v[110:111], v[88:89], v[94:95] op_sel:[0,1,0] op_sel_hi:[1,1,1]
    v_lshlrev_b32 v108, 16, v74
    v_and_b32 v109, 0xffff0000, v74
    v_pk_fma_f32 v[96:97], v[108:109], v[88:89], v[96:97] op_sel:[0,1,0] op_sel_hi:[1,1,1]
    v_lshlrev_b32 v110, 16, v75
    v_and_b32 v111, 0xffff0000, v75
    v_pk_fma_f32 v[98:99], v[110:111], v[88:89], v[98:99] op_sel:[0,1,0] op_sel_hi:[1,1,1]
    v_add_f32_dpp v92, v92, v92 row_ror:8 row_mask:0xf bank_mask:0xf
    v_add_f32_dpp v93, v93, v93 row_ror:8 row_mask:0xf bank_mask:0xf
    v_add_f32_dpp v94, v94, v94 row_ror:8 row_mask:0xf bank_mask:0xf
    v_add_f32_dpp v95, v95, v95 row_ror:8 row_mask:0xf bank_mask:0xf
    v_add_f32_dpp v96, v96, v96 row_ror:8 row_mask:0xf bank_mask:0xf
    v_add_f32_dpp v97, v97, v97 row_ror:8 row_mask:0xf bank_mask:0xf
    v_add_f32_dpp v98, v98, v98 row_ror:8 row_mask:0xf bank_mask:0xf
    v_add_f32_dpp v99, v99, v99 row_ror:8 row_mask:0xf bank_mask:0xf
    s_lshl_b32 s72, s70, 10
    s_add_u32 s72, s72, 0x24800
    v_lshlrev_b32 v10, 8, v3
    v_lshl_add_u32 v10, v2, 5, v10
    v_add_u32 v10, s72, v10
    v_cmp_gt_u32 vcc, 8, v2
    s_nop 0
    s_and_saveexec_b64 s[26:27], vcc
    ds_write_b128 v10, v[92:95]
    ds_write_b128 v10, v[96:99] offset:16
    s_mov_b64 exec, 1
    s_waitcnt lgkmcnt(0)
    v_mov_b32 v18, 0x27210
    v_mov_b32 v19, 1
    ds_add_rtn_u32 v19, v18, v19
    s_mov_b64 exec, -1
    s_waitcnt lgkmcnt(0)
    v_readfirstlane_b32 s72, v19
    s_nop 0
    s_cmp_lg_u32 s72, 3
    s_cbranch_scc1 L_nomod
    v_readfirstlane_b32 s71, v112
    s_nop 0
    s_cmp_lg_u32 s71, 0
    s_cbranch_scc1 L_mod_hn
    s_cmp_eq_u32 s2, 0
    s_cbranch_scc1 nlpd_3
    v_mov_b32 v10, 0
    s_mov_b32 s101, 0
nlp_2:
    buffer_load_dword v11, v10, s[64:67], 0 offen sc1
    s_add_u32 s101, s101, 1
    s_cmp_gt_u32 s101, 0x61a80
    s_cbranch_scc1 nlpd_3
    s_waitcnt vmcnt(0)
    v_readfirstlane_b32 s71, v11
    s_nop 0
    s_cmp_eq_u32 s71, 0
    s_cbranch_scc1 nlp_2
nlpd_3:
L_mod_hn:
    s_nop 1
    v_lshrrev_b32 v10, 5, v1
    v_lshlrev_b32 v10, 11, v10
    v_and_b32 v11, 31, v1
    v_lshl_add_u32 v10, v11, 3, v10
    v_add_u32 v10, 0x24800, v10
    ds_read_b64 v[20:21], v10 offset:0
    ds_read_b64 v[22:23], v10 offset:256
    ds_read_b64 v[24:25], v10 offset:512
    ds_read_b64 v[26:27], v10 offset:768
    ds_read_b64 v[28:29], v10 offset:1024
    ds_read_b64 v[30:31], v10 offset:1280
    ds_read_b64 v[32:33], v10 offset:1536
    ds_read_b64 v[34:35], v10 offset:1792
    s_waitcnt lgkmcnt(0)
    v_pk_add_f32 v[20:21], v[20:21], v[22:23]
    v_pk_add_f32 v[28:29], v[28:29], v[30:31]
    v_pk_add_f32 v[20:21], v[20:21], v[24:25]
    v_pk_add_f32 v[28:29], v[28:29], v[32:33]
    v_pk_add_f32 v[20:21], v[20:21], v[26:27]
    v_pk_add_f32 v[28:29], v[28:29], v[34:35]
    v_pk_add_f32 v[20:21], v[20:21], v[28:29]
    v_mov_b32 v12, v20
    v_mov_b32 v13, v21
    s_nop 0
    v_permlane32_swap_b32 v20, v12
    v_permlane32_swap_b32 v21, v13
    v_add_f32 v20, v20, v12
    v_add_f32 v21, v21, v13
    v_cvt_pk_bf16_f32 v22, v20, v21
    v_mov_b32 v23, s71
    v_lshlrev_b32 v10, 3, v1
    s_lshl_b32 s72, s68, 8
    s_mov_b32 exec_hi, 0
    buffer_store_dwordx2 v[22:23], v10, s[60:63], s72 offen offset:0 sc1
    s_mov_b64 exec, -1
L_nomod:
    s_nop 0
    v_cmp_gt_u32 vcc, 56, v1
    v_mov_b32 v10, 0x10000000
    s_nop 0
    v_cndmask_b32 v6, v10, v4, vcc
    s_mul_i32 s72, s89, 10
    s_add_u32 s72, s72, s100
    s_sub_u32 s72, s72, 16
    s_max_i32 s73, s72, 0
    s_mul_i32 s73, s73, 0x380
    buffer_load_dwordx4 v[176:179], v6, s[28:31], s73 offen
    s_add_u32 s72, s72, 1
    s_max_i32 s73, s72, 0
    s_mul_i32 s73, s73, 0x380
    buffer_load_dwordx4 v[180:183], v6, s[28:31], s73 offen
    s_add_u32 s72, s72, 1
    s_max_i32 s73, s72, 0
    s_mul_i32 s73, s73, 0x380
    buffer_load_dwordx4 v[184:187], v6, s[28:31], s73 offen
    s_add_u32 s72, s72, 1
    s_max_i32 s73, s72, 0
    s_mul_i32 s73, s73, 0x380
    buffer_load_dwordx4 v[188:191], v6, s[28:31], s73 offen
    s_add_u32 s72, s72, 1
    s_max_i32 s73, s72, 0
    s_mul_i32 s73, s73, 0x380
    buffer_load_dwordx4 v[192:195], v6, s[28:31], s73 offen
    s_add_u32 s72, s72, 1
    s_max_i32 s73, s72, 0
    s_mul_i32 s73, s73, 0x380
    buffer_load_dwordx4 v[196:199], v6, s[28:31], s73 offen
    s_add_u32 s72, s72, 1
    s_max_i32 s73, s72, 0
    s_mul_i32 s73, s73, 0x380
    buffer_load_dwordx4 v[200:203], v6, s[28:31], s73 offen
    s_add_u32 s72, s72, 1
    s_max_i32 s73, s72, 0
    s_mul_i32 s73, s73, 0x380
    buffer_load_dwordx4 v[204:207], v6, s[28:31], s73 offen
    s_add_u32 s72, s72, 1
    s_max_i32 s73, s72, 0
    s_mul_i32 s73, s73, 0x380
    buffer_load_dwordx4 v[208:211], v6, s[28:31], s73 offen
    s_add_u32 s72, s72, 1
    s_max_i32 s73, s72, 0
    s_mul_i32 s73, s73, 0x380
    buffer_load_dwordx4 v[212:215], v6, s[28:31], s73 offen
    s_cmp_lg_u32 s78, -1
    s_cbranch_scc1 L_noxb
    s_barrier
L_noxb:
    v_min_u32 v255, 55, v1
    v_lshlrev_b32 v255, 5, v255
    s_cmp_ge_u32 s70, 4
    s_cbranch_scc1 L_g1
    s_mul_i32 s72, s3, 3
    s_lshr_b32 s72, s72, 1
    s_mul_i32 s73, s72, 0x15000
    s_add_u32 s82, s82, s73
    s_mul_i32 s73, s72, 0x3000
    s_add_u32 s73, s73, s81
    s_add_u32 m0, s73, 0
    s_nop 0
    buffer_load_dwordx4 v254, s[32:35], s82 offen lds
    s_add_u32 s82, s82, 0x380
    s_add_u32 m0, s73, 0x1000
    s_nop 0
    buffer_load_dwordx4 v254, s[32:35], s82 offen lds
    s_add_u32 s82, s82, 0x380
    s_add_u32 m0, s73, 0x2000
    s_nop 0
    buffer_load_dwordx4 v254, s[32:35], s82 offen lds
    s_add_u32 s82, s82, 0x14900
    s_add_u32 s73, s73, 0x3000
    s_add_u32 s72, s72, 1
    s_cmp_eq_u32 s72, 6
    s_cselect_b32 s74, 0x7e000, 0
    s_sub_u32 s82, s82, s74
    s_cmp_eq_u32 s72, 6
    s_cselect_b32 s74, 0x12000, 0
    s_sub_u32 s73, s73, s74
    s_add_u32 m0, s73, 0
    s_nop 0
    buffer_load_dwordx4 v254, s[32:35], s82 offen lds
    s_add_u32 s82, s82, 0x380
    s_add_u32 m0, s73, 0x1000
    s_nop 0
    buffer_load_dwordx4 v254, s[32:35], s82 offen lds
    s_add_u32 s82, s82, 0x380
    s_add_u32 m0, s73, 0x2000
    s_nop 0
    buffer_load_dwordx4 v254, s[32:35], s82 offen lds
    s_add_u32 s82, s82, 0x14900
    s_add_u32 s73, s73, 0x3000
    s_add_u32 s72, s72, 1
    s_cmp_eq_u32 s72, 6
    s_cselect_b32 s74, 0x7e000, 0
    s_sub_u32 s82, s82, s74
    s_cmp_eq_u32 s72, 6
    s_cselect_b32 s74, 0x12000, 0
    s_sub_u32 s73, s73, s74
    s_add_u32 m0, s73, 0
    s_nop 0
    buffer_load_dwordx4 v254, s[32:35], s82 offen lds
    s_add_u32 s82, s82, 0x380
    s_add_u32 m0, s73, 0x1000
    s_nop 0
    buffer_load_dwordx4 v254, s[32:35], s82 offen lds
    s_add_u32 s82, s82, 0x380
    s_add_u32 m0, s73, 0x2000
    s_nop 0
    buffer_load_dwordx4 v254, s[32:35], s82 offen lds
    s_add_u32 s82, s82, 0x14900
    s_add_u32 s73, s73, 0x3000
    s_add_u32 s72, s72, 1
    s_cmp_eq_u32 s72, 6
    s_cselect_b32 s74, 0x7e000, 0
    s_sub_u32 s82, s82, s74
    s_cmp_eq_u32 s72, 6
    s_cselect_b32 s74, 0x12000, 0
    s_sub_u32 s73, s73, s74
    s_add_u32 m0, s73, 0
    s_nop 0
    buffer_load_dwordx4 v254, s[32:35], s82 offen lds
    s_add_u32 s82, s82, 0x380
    s_add_u32 m0, s73, 0x1000
    s_nop 0
    buffer_load_dwordx4 v254, s[32:35], s82 offen lds
    s_add_u32 s82, s82, 0x380
    s_add_u32 m0, s73, 0x2000
    s_nop 0
    buffer_load_dwordx4 v254, s[32:35], s82 offen lds
    s_add_u32 s82, s82, 0x14900
    s_add_u32 s73, s73, 0x3000
    s_add_u32 s72, s72, 1
    s_cmp_eq_u32 s72, 6
    s_cselect_b32 s74, 0x7e000, 0
    s_sub_u32 s82, s82, s74
    s_cmp_eq_u32 s72, 6
    s_cselect_b32 s74, 0x12000, 0
    s_sub_u32 s73, s73, s74
    s_add_u32 m0, s73, 0
    s_nop 0
    buffer_load_dwordx4 v254, s[32:35], s82 offen lds
    s_add_u32 s82, s82, 0x380
    s_add_u32 m0, s73, 0x1000
    s_nop 0
    buffer_load_dwordx4 v254, s[32:35], s82 offen lds
    s_add_u32 s82, s82, 0x380
    s_add_u32 m0, s73, 0x2000
    s_nop 0
    buffer_load_dwordx4 v254, s[32:35], s82 offen lds
    s_add_u32 s82, s82, 0x14900
    s_add_u32 s73, s73, 0x3000
    s_add_u32 s72, s72, 1
    s_cmp_eq_u32 s72, 6
    s_cselect_b32 s74, 0x7e000, 0
    s_sub_u32 s82, s82, s74
    s_cmp_eq_u32 s72, 6
    s_cselect_b32 s74, 0x12000, 0
    s_sub_u32 s73, s73, s74
    s_add_u32 m0, s73, 0
    s_nop 0
    buffer_load_dwordx4 v254, s[32:35], s82 offen lds
    s_add_u32 s82, s82, 0x380
    s_add_u32 m0, s73, 0x1000
    s_nop 0
    buffer_load_dwordx4 v254, s[32:35], s82 offen lds
    s_add_u32 s82, s82, 0x380
    s_add_u32 m0, s73, 0x2000
    s_nop 0
    buffer_load_dwordx4 v254, s[32:35], s82 offen lds
    s_add_u32 s82, s82, 0x14900
    s_waitcnt vmcnt(18)
    s_mov_b32 s75, 0x3f803f80
    v_dot2_f32_bf16 v216, v176, s75, 0
    v_dot2_f32_bf16 v228, v176, v176, 0
    v_dot2_f32_bf16 v216, v177, s75, v216
    v_dot2_f32_bf16 v228, v177, v177, v228
    v_dot2_f32_bf16 v216, v178, s75, v216
    v_dot2_f32_bf16 v228, v178, v178, v228
    v_dot2_f32_bf16 v216, v179, s75, v216
    v_dot2_f32_bf16 v228, v179, v179, v228
    v_dot2_f32_bf16 v217, v180, s75, 0
    v_dot2_f32_bf16 v229, v180, v180, 0
    v_dot2_f32_bf16 v217, v181, s75, v217
    v_dot2_f32_bf16 v229, v181, v181, v229
    v_dot2_f32_bf16 v217, v182, s75, v217
    v_dot2_f32_bf16 v229, v182, v182, v229
    v_dot2_f32_bf16 v217, v183, s75, v217
    v_dot2_f32_bf16 v229, v183, v183, v229
    v_dot2_f32_bf16 v218, v184, s75, 0
    v_dot2_f32_bf16 v230, v184, v184, 0
    v_dot2_f32_bf16 v218, v185, s75, v218
    v_dot2_f32_bf16 v230, v185, v185, v230
    v_dot2_f32_bf16 v218, v186, s75, v218
    v_dot2_f32_bf16 v230, v186, v186, v230
    v_dot2_f32_bf16 v218, v187, s75, v218
    v_dot2_f32_bf16 v230, v187, v187, v230
    v_dot2_f32_bf16 v219, v188, s75, 0
    v_dot2_f32_bf16 v231, v188, v188, 0
    v_dot2_f32_bf16 v219, v189, s75, v219
    v_dot2_f32_bf16 v231, v189, v189, v231
    v_dot2_f32_bf16 v219, v190, s75, v219
    v_dot2_f32_bf16 v231, v190, v190, v231
    v_dot2_f32_bf16 v219, v191, s75, v219
    v_dot2_f32_bf16 v231, v191, v191, v231
    v_dot2_f32_bf16 v220, v192, s75, 0
    v_dot2_f32_bf16 v232, v192, v192, 0
    v_dot2_f32_bf16 v220, v193, s75, v220
    v_dot2_f32_bf16 v232, v193, v193, v232
    v_dot2_f32_bf16 v220, v194, s75, v220
    v_dot2_f32_bf16 v232, v194, v194, v232
    v_dot2_f32_bf16 v220, v195, s75, v220
    v_dot2_f32_bf16 v232, v195, v195, v232
    v_dot2_f32_bf16 v221, v196, s75, 0
    v_dot2_f32_bf16 v233, v196, v196, 0
    v_dot2_f32_bf16 v221, v197, s75, v221
    v_dot2_f32_bf16 v233, v197, v197, v233
    v_dot2_f32_bf16 v221, v198, s75, v221
    v_dot2_f32_bf16 v233, v198, v198, v233
    v_dot2_f32_bf16 v221, v199, s75, v221
    v_dot2_f32_bf16 v233, v199, v199, v233
    v_dot2_f32_bf16 v222, v200, s75, 0
    v_dot2_f32_bf16 v234, v200, v200, 0
    v_dot2_f32_bf16 v222, v201, s75, v222
    v_dot2_f32_bf16 v234, v201, v201, v234
    v_dot2_f32_bf16 v222, v202, s75, v222
    v_dot2_f32_bf16 v234, v202, v202, v234
    v_dot2_f32_bf16 v222, v203, s75, v222
    v_dot2_f32_bf16 v234, v203, v203, v234
    v_dot2_f32_bf16 v223, v204, s75, 0
    v_dot2_f32_bf16 v235, v204, v204, 0
    v_dot2_f32_bf16 v223, v205, s75, v223
    v_dot2_f32_bf16 v235, v205, v205, v235
    v_dot2_f32_bf16 v223, v206, s75, v223
    v_dot2_f32_bf16 v235, v206, v206, v235
    v_dot2_f32_bf16 v223, v207, s75, v223
    v_dot2_f32_bf16 v235, v207, v207, v235
    v_dot2_f32_bf16 v224, v208, s75, 0
    v_dot2_f32_bf16 v236, v208, v208, 0
    v_dot2_f32_bf16 v224, v209, s75, v224
    v_dot2_f32_bf16 v236, v209, v209, v236
    v_dot2_f32_bf16 v224, v210, s75, v224
    v_dot2_f32_bf16 v236, v210, v210, v236
    v_dot2_f32_bf16 v224, v211, s75, v224
    v_dot2_f32_bf16 v236, v211, v211, v236
    v_dot2_f32_bf16 v225, v212, s75, 0
    v_dot2_f32_bf16 v237, v212, v212, 0
    v_dot2_f32_bf16 v225, v213, s75, v225
    v_dot2_f32_bf16 v237, v213, v213, v237
    v_dot2_f32_bf16 v225, v214, s75, v225
    v_dot2_f32_bf16 v237, v214, v214, v237
    v_dot2_f32_bf16 v225, v215, s75, v225
    v_dot2_f32_bf16 v237, v215, v215, v237
    v_mov_b32 v226, 0
    v_mov_b32 v238, 0
    v_mov_b32 v227, 0
    v_mov_b32 v239, 0
    v_permlane32_swap_b32 v216, v218
    v_permlane32_swap_b32 v217, v219
    v_add_f32 v216, v216, v218
    v_add_f32 v217, v217, v219
    s_nop 1
    v_permlane16_swap_b32 v216, v217
    v_add_f32 v216, v216, v217
    s_nop 1
    v_add_f32_dpp v216, v216, v216 row_ror:8 row_mask:0xf bank_mask:0xf
    s_nop 1
    v_add_f32_dpp v216, v216, v216 row_ror:4 row_mask:0xf bank_mask:0xf
    s_nop 1
    v_add_f32_dpp v216, v216, v216 row_ror:2 row_mask:0xf bank_mask:0xf
    s_nop 1
    v_add_f32_dpp v216, v216, v216 row_ror:1 row_mask:0xf bank_mask:0xf
    v_permlane32_swap_b32 v228, v230
    v_permlane32_swap_b32 v229, v231
    v_add_f32 v228, v228, v230
    v_add_f32 v229, v229, v231
    s_nop 1
    v_permlane16_swap_b32 v228, v229
    v_add_f32 v228, v228, v229
    s_nop 1
    v_add_f32_dpp v228, v228, v228 row_ror:8 row_mask:0xf bank_mask:0xf
    s_nop 1
    v_add_f32_dpp v228, v228, v228 row_ror:4 row_mask:0xf bank_mask:0xf
    s_nop 1
    v_add_f32_dpp v228, v228, v228 row_ror:2 row_mask:0xf bank_mask:0xf
    s_nop 1
    v_add_f32_dpp v228, v228, v228 row_ror:1 row_mask:0xf bank_mask:0xf
    v_permlane32_swap_b32 v220, v222
    v_permlane32_swap_b32 v221, v223
    v_add_f32 v220, v220, v222
    v_add_f32 v221, v221, v223
    s_nop 1
    v_permlane16_swap_b32 v220, v221
    v_add_f32 v220, v220, v221
    s_nop 1
    v_add_f32_dpp v220, v220, v220 row_ror:8 row_mask:0xf bank_mask:0xf
    s_nop 1
    v_add_f32_dpp v220, v220, v220 row_ror:4 row_mask:0xf bank_mask:0xf
    s_nop 1
    v_add_f32_dpp v220, v220, v220 row_ror:2 row_mask:0xf bank_mask:0xf
    s_nop 1
    v_add_f32_dpp v220, v220, v220 row_ror:1 row_mask:0xf bank_mask:0xf
    v_permlane32_swap_b32 v232, v234
    v_permlane32_swap_b32 v233, v235
    v_add_f32 v232, v232, v234
    v_add_f32 v233, v233, v235
    s_nop 1
    v_permlane16_swap_b32 v232, v233
    v_add_f32 v232, v232, v233
    s_nop 1
    v_add_f32_dpp v232, v232, v232 row_ror:8 row_mask:0xf bank_mask:0xf
    s_nop 1
    v_add_f32_dpp v232, v232, v232 row_ror:4 row_mask:0xf bank_mask:0xf
    s_nop 1
    v_add_f32_dpp v232, v232, v232 row_ror:2 row_mask:0xf bank_mask:0xf
    s_nop 1
    v_add_f32_dpp v232, v232, v232 row_ror:1 row_mask:0xf bank_mask:0xf
    v_permlane32_swap_b32 v224, v226
    v_permlane32_swap_b32 v225, v227
    v_add_f32 v224, v224, v226
    v_add_f32 v225, v225, v227
    s_nop 1
    v_permlane16_swap_b32 v224, v225
    v_add_f32 v224, v224, v225
    s_nop 1
    v_add_f32_dpp v224, v224, v224 row_ror:8 row_mask:0xf bank_mask:0xf
    s_nop 1
    v_add_f32_dpp v224, v224, v224 row_ror:4 row_mask:0xf bank_mask:0xf
    s_nop 1
    v_add_f32_dpp v224, v224, v224 row_ror:2 row_mask:0xf bank_mask:0xf
    s_nop 1
    v_add_f32_dpp v224, v224, v224 row_ror:1 row_mask:0xf bank_mask:0xf
    v_permlane32_swap_b32 v236, v238
    v_permlane32_swap_b32 v237, v239
    v_add_f32 v236, v236, v238
    v_add_f32 v237, v237, v239
    s_nop 1
    v_permlane16_swap_b32 v236, v237
    v_add_f32 v236, v236, v237
    s_nop 1
    v_add_f32_dpp v236, v236, v236 row_ror:8 row_mask:0xf bank_mask:0xf
    s_nop 1
    v_add_f32_dpp v236, v236, v236 row_ror:4 row_mask:0xf bank_mask:0xf
    s_nop 1
    v_add_f32_dpp v236, v236, v236 row_ror:2 row_mask:0xf bank_mask:0xf
    s_nop 1
    v_add_f32_dpp v236, v236, v236 row_ror:1 row_mask:0xf bank_mask:0xf
    v_cmp_eq_u32 s[92:93], 1, v2
    v_cmp_eq_u32 s[94:95], 2, v2
    s_nop 0
    v_cndmask_b32 v216, v216, v220, s[92:93]
    v_cndmask_b32 v216, v216, v224, s[94:95]
    v_cndmask_b32 v228, v228, v232, s[92:93]
    v_cndmask_b32 v228, v228, v236, s[94:95]
    v_mul_f32 v216, 0x3b124925, v216
    v_mul_f32 v228, 0x3b124925, v228
    v_fma_f32 v228, -v216, v216, v228
    v_max_f32 v228, 0, v228
    v_cvt_pk_bf16_f32 v12, v216, v228
    v_lshlrev_b32 v10, 16, v12
    v_and_b32 v11, 0xffff0000, v12
    v_add_f32 v11, 0x3727c5ac, v11
    v_cvt_pk_bf16_f32 v12, v11, v11
    v_lshlrev_b32 v11, 16, v12
    v_sqrt_f32 v11, v11
    s_nop 0
    v_cvt_pk_bf16_f32 v12, v11, v11
    v_lshlrev_b32 v11, 16, v12
    v_rcp_f32 v216, v11
    s_nop 0
    v_mul_f32 v228, -v10, v216
    v_readlane_b32 s4, v216, 0
    v_readlane_b32 s5, v228, 0
    v_readlane_b32 s6, v216, 16
    v_readlane_b32 s7, v228, 16
    v_readlane_b32 s8, v216, 32
    v_readlane_b32 s9, v228, 32
    v_readlane_b32 s10, v216, 48
    v_readlane_b32 s11, v228, 48
    v_readlane_b32 s12, v216, 1
    v_readlane_b32 s13, v228, 1
    v_readlane_b32 s14, v216, 17
    v_readlane_b32 s15, v228, 17
    v_readlane_b32 s16, v216, 33
    v_readlane_b32 s17, v228, 33
    v_readlane_b32 s18, v216, 49
    v_readlane_b32 s19, v228, 49
    v_readlane_b32 s20, v216, 2
    v_readlane_b32 s21, v228, 2
    v_readlane_b32 s22, v216, 18
    v_readlane_b32 s23, v228, 18
    v_mov_b32 v14, s5
    v_lshlrev_b32 v136, 16, v176
    v_and_b32 v137, 0xffff0000, v176
    v_lshlrev_b32 v138, 16, v177
    v_and_b32 v139, 0xffff0000, v177
    v_lshlrev_b32 v140, 16, v178
    v_and_b32 v141, 0xffff0000, v178
    v_lshlrev_b32 v142, 16, v179
    v_and_b32 v143, 0xffff0000, v179
    v_pk_fma_f32 v[136:137], v[136:137], s[4:5], v[14:15] op_sel_hi:[1,0,0]
    v_pk_fma_f32 v[138:139], v[138:139], s[4:5], v[14:15] op_sel_hi:[1,0,0]
    v_pk_fma_f32 v[140:141], v[140:141], s[4:5], v[14:15] op_sel_hi:[1,0,0]
    v_pk_fma_f32 v[142:143], v[142:143], s[4:5], v[14:15] op_sel_hi:[1,0,0]
    v_mov_b32 v14, s7
    v_lshlrev_b32 v144, 16, v180
    v_and_b32 v145, 0xffff0000, v180
    v_lshlrev_b32 v146, 16, v181
    v_and_b32 v147, 0xffff0000, v181
    v_lshlrev_b32 v148, 16, v182
    v_and_b32 v149, 0xffff0000, v182
    v_lshlrev_b32 v150, 16, v183
    v_and_b32 v151, 0xffff0000, v183
    v_pk_fma_f32 v[144:145], v[144:145], s[6:7], v[14:15] op_sel_hi:[1,0,0]
    v_pk_fma_f32 v[146:147], v[146:147], s[6:7], v[14:15] op_sel_hi:[1,0,0]
    v_pk_fma_f32 v[148:149], v[148:149], s[6:7], v[14:15] op_sel_hi:[1,0,0]
    v_pk_fma_f32 v[150:151], v[150:151], s[6:7], v[14:15] op_sel_hi:[1,0,0]
    v_mov_b32 v14, s9
    v_lshlrev_b32 v152, 16, v184
    v_and_b32 v153, 0xffff0000, v184
    v_lshlrev_b32 v154, 16, v185
    v_and_b32 v155, 0xffff0000, v185
    v_lshlrev_b32 v156, 16, v186
    v_and_b32 v157, 0xffff0000, v186
    v_lshlrev_b32 v158, 16, v187
    v_and_b32 v159, 0xffff0000, v187
    v_pk_fma_f32 v[152:153], v[152:153], s[8:9], v[14:15] op_sel_hi:[1,0,0]
    v_pk_fma_f32 v[154:155], v[154:155], s[8:9], v[14:15] op_sel_hi:[1,0,0]
    v_pk_fma_f32 v[156:157], v[156:157], s[8:9], v[14:15] op_sel_hi:[1,0,0]
    v_pk_fma_f32 v[158:159], v[158:159], s[8:9], v[14:15] op_sel_hi:[1,0,0]
    s_waitcnt vmcnt(0)
    s_lshl_b32 s72, s70, 2
    v_add_u32 v18, s72, v8
    v_mov_b32 v19, 1
    ds_write_b32 v18, v19 offset:224
    v_mov_b32 v14, s11
    v_lshlrev_b32 v160, 16, v188
    v_and_b32 v161, 0xffff0000, v188
    v_lshlrev_b32 v162, 16, v189
    v_and_b32 v163, 0xffff0000, v189
    v_lshlrev_b32 v164, 16, v190
    v_and_b32 v165, 0xffff0000, v190
    v_lshlrev_b32 v166, 16, v191
    v_and_b32 v167, 0xffff0000, v191
    v_pk_fma_f32 v[160:161], v[160:161], s[10:11], v[14:15] op_sel_hi:[1,0,0]
    v_pk_fma_f32 v[162:163], v[162:163], s[10:11], v[14:15] op_sel_hi:[1,0,0]
    v_pk_fma_f32 v[164:165], v[164:165], s[10:11], v[14:15] op_sel_hi:[1,0,0]
    v_pk_fma_f32 v[166:167], v[166:167], s[10:11], v[14:15] op_sel_hi:[1,0,0]
    v_mov_b32 v14, s13
    v_lshlrev_b32 v168, 16, v192
    v_and_b32 v169, 0xffff0000, v192
    v_lshlrev_b32 v170, 16, v193
    v_and_b32 v171, 0xffff0000, v193
    v_lshlrev_b32 v172, 16, v194
    v_and_b32 v173, 0xffff0000, v194
    v_lshlrev_b32 v174, 16, v195
    v_and_b32 v175, 0xffff0000, v195
    v_pk_fma_f32 v[168:169], v[168:169], s[12:13], v[14:15] op_sel_hi:[1,0,0]
    v_pk_fma_f32 v[170:171], v[170:171], s[12:13], v[14:15] op_sel_hi:[1,0,0]
    v_pk_fma_f32 v[172:173], v[172:173], s[12:13], v[14:15] op_sel_hi:[1,0,0]
    v_pk_fma_f32 v[174:175], v[174:175], s[12:13], v[14:15] op_sel_hi:[1,0,0]
    v_mov_b32 v14, s15
    v_lshlrev_b32 v176, 16, v196
    v_and_b32 v177, 0xffff0000, v196
    v_lshlrev_b32 v178, 16, v197
    v_and_b32 v179, 0xffff0000, v197
    v_lshlrev_b32 v180, 16, v198
    v_and_b32 v181, 0xffff0000, v198
    v_lshlrev_b32 v182, 16, v199
    v_and_b32 v183, 0xffff0000, v199
    v_pk_fma_f32 v[176:177], v[176:177], s[14:15], v[14:15] op_sel_hi:[1,0,0]
    v_pk_fma_f32 v[178:179], v[178:179], s[14:15], v[14:15] op_sel_hi:[1,0,0]
    v_pk_fma_f32 v[180:181], v[180:181], s[14:15], v[14:15] op_sel_hi:[1,0,0]
    v_pk_fma_f32 v[182:183], v[182:183], s[14:15], v[14:15] op_sel_hi:[1,0,0]
    v_mov_b32 v14, s17
    v_lshlrev_b32 v184, 16, v200
    v_and_b32 v185, 0xffff0000, v200
    v_lshlrev_b32 v186, 16, v201
    v_and_b32 v187, 0xffff0000, v201
    v_lshlrev_b32 v188, 16, v202
    v_and_b32 v189, 0xffff0000, v202
    v_lshlrev_b32 v190, 16, v203
    v_and_b32 v191, 0xffff0000, v203
    v_pk_fma_f32 v[184:185], v[184:185], s[16:17], v[14:15] op_sel_hi:[1,0,0]
    v_pk_fma_f32 v[186:187], v[186:187], s[16:17], v[14:15] op_sel_hi:[1,0,0]
    v_pk_fma_f32 v[188:189], v[188:189], s[16:17], v[14:15] op_sel_hi:[1,0,0]
    v_pk_fma_f32 v[190:191], v[190:191], s[16:17], v[14:15] op_sel_hi:[1,0,0]
    v_mov_b32 v14, s19
    v_lshlrev_b32 v192, 16, v204
    v_and_b32 v193, 0xffff0000, v204
    v_lshlrev_b32 v194, 16, v205
    v_and_b32 v195, 0xffff0000, v205
    v_lshlrev_b32 v196, 16, v206
    v_and_b32 v197, 0xffff0000, v206
    v_lshlrev_b32 v198, 16, v207
    v_and_b32 v199, 0xffff0000, v207
    v_pk_fma_f32 v[192:193], v[192:193], s[18:19], v[14:15] op_sel_hi:[1,0,0]
    v_pk_fma_f32 v[194:195], v[194:195], s[18:19], v[14:15] op_sel_hi:[1,0,0]
    v_pk_fma_f32 v[196:197], v[196:197], s[18:19], v[14:15] op_sel_hi:[1,0,0]
    v_pk_fma_f32 v[198:199], v[198:199], s[18:19], v[14:15] op_sel_hi:[1,0,0]
    v_mov_b32 v14, s21
    v_lshlrev_b32 v200, 16, v208
    v_and_b32 v201, 0xffff0000, v208
    v_lshlrev_b32 v202, 16, v209
    v_and_b32 v203, 0xffff0000, v209
    v_lshlrev_b32 v204, 16, v210
    v_and_b32 v205, 0xffff0000, v210
    v_lshlrev_b32 v206, 16, v211
    v_and_b32 v207, 0xffff0000, v211
    v_pk_fma_f32 v[200:201], v[200:201], s[20:21], v[14:15] op_sel_hi:[1,0,0]
    v_pk_fma_f32 v[202:203], v[202:203], s[20:21], v[14:15] op_sel_hi:[1,0,0]
    v_pk_fma_f32 v[204:205], v[204:205], s[20:21], v[14:15] op_sel_hi:[1,0,0]
    v_pk_fma_f32 v[206:207], v[206:207], s[20:21], v[14:15] op_sel_hi:[1,0,0]
    v_mov_b32 v14, s23
    v_mov_b32 v10, v212
    v_mov_b32 v11, v213
    v_mov_b32 v12, v214
    v_mov_b32 v13, v215
    v_lshlrev_b32 v208, 16, v10
    v_and_b32 v209, 0xffff0000, v10
    v_lshlrev_b32 v210, 16, v11
    v_and_b32 v211, 0xffff0000, v11
    v_lshlrev_b32 v212, 16, v12
    v_and_b32 v213, 0xffff0000, v12
    v_lshlrev_b32 v214, 16, v13
    v_and_b32 v215, 0xffff0000, v13
    v_pk_fma_f32 v[208:209], v[208:209], s[22:23], v[14:15] op_sel_hi:[1,0,0]
    v_pk_fma_f32 v[210:211], v[210:211], s[22:23], v[14:15] op_sel_hi:[1,0,0]
    v_pk_fma_f32 v[212:213], v[212:213], s[22:23], v[14:15] op_sel_hi:[1,0,0]
    v_pk_fma_f32 v[214:215], v[214:215], s[22:23], v[14:15] op_sel_hi:[1,0,0]
    s_mov_b32 s101, 0
lw_4:
    ds_read_b128 v[16:19], v8 offset:224
    s_add_u32 s101, s101, 1
    s_cmp_gt_u32 s101, 0x3d0900
    s_cbranch_scc1 lwd_5
    s_waitcnt lgkmcnt(0)
    v_min_u32 v18, v18, v19
    v_min3_u32 v18, v18, v16, v17
    s_nop 0
    v_readfirstlane_b32 s79, v18
    s_nop 0
    s_cmp_ge_u32 s79, 1
    s_cbranch_scc1 lwd_5
    s_branch lw_4
lwd_5:
    s_nop 0
    ds_read_b64_tr_b16 v[20:21], v250 offset:0
    ds_read_b64_tr_b16 v[22:23], v250 offset:512
    ds_read_b64_tr_b16 v[24:25], v251 offset:0
    ds_read_b64_tr_b16 v[26:27], v251 offset:512
    ds_read_b64_tr_b16 v[28:29], v250 offset:12288
    ds_read_b64_tr_b16 v[30:31], v250 offset:12800
    ds_read_b64_tr_b16 v[32:33], v251 offset:12288
    ds_read_b64_tr_b16 v[34:35], v251 offset:12800
    ds_read_b64_tr_b16 v[36:37], v250 offset:24576
    ds_read_b64_tr_b16 v[38:39], v250 offset:25088
    ds_read_b64_tr_b16 v[40:41], v251 offset:24576
    ds_read_b64_tr_b16 v[42:43], v251 offset:25088
    s_waitcnt lgkmcnt(11)
    ds_read_b64_tr_b16 v[44:45], v250 offset:36864
    ds_read_b64_tr_b16 v[46:47], v250 offset:37376
    ds_read_b64_tr_b16 v[48:49], v251 offset:36864
    ds_read_b64_tr_b16 v[50:51], v251 offset:37376
    s_waitcnt lgkmcnt(11)
    ds_read_b64_tr_b16 v[52:53], v250 offset:49152
    ds_read_b64_tr_b16 v[54:55], v250 offset:49664
    ds_read_b64_tr_b16 v[56:57], v251 offset:49152
    ds_read_b64_tr_b16 v[58:59], v251 offset:49664
    s_waitcnt lgkmcnt(11)
    ds_read_b64_tr_b16 v[60:61], v250 offset:61440
    ds_read_b64_tr_b16 v[62:63], v250 offset:61952
    ds_read_b64_tr_b16 v[64:65], v251 offset:61440
    ds_read_b64_tr_b16 v[66:67], v251 offset:61952
    s_waitcnt lgkmcnt(14)
    v_mov_b32 v19, 1
    s_mov_b64 exec, 1
    ds_add_u32 v8, v19 offset:20
    s_mov_b64 exec, -1
    v_mov_b32 v18, 0x27220
    s_mov_b32 s101, 0
bc_6:
    ds_read_b32 v19, v18
    s_add_u32 s101, s101, 1
    s_cmp_gt_u32 s101, 0x3d0900
    s_cbranch_scc1 bcd_7
    s_waitcnt lgkmcnt(0)
    v_readfirstlane_b32 s71, v19
    s_nop 0
    s_cmp_eq_u32 s71, 0
    s_cbranch_scc1 bc_6
bcd_7:
    v_lshlrev_b32 v18, 1, v255
    v_add_u32 v18, 0x25800, v18
    ds_read_b128 v[232:235], v18 offset:0
    ds_read_b128 v[236:239], v18 offset:16
    ds_read_b128 v[240:243], v18 offset:32
    ds_read_b128 v[244:247], v18 offset:48
    s_waitcnt lgkmcnt(0)
    s_mov_b32 s101, 0
lw_8:
    ds_read_b32 v18, v8 offset:20
    s_add_u32 s101, s101, 1
    s_cmp_gt_u32 s101, 0x3d0900
    s_cbranch_scc1 lwd_9
    s_waitcnt lgkmcnt(0)
    v_readfirstlane_b32 s79, v18
    s_nop 0
    s_cmp_ge_u32 s79, 8
    s_cbranch_scc1 lwd_9
    s_branch lw_8
lwd_9:
    s_nop 0
    s_mul_i32 s72, s89, 0x2440
    v_add_u32 v11, s72, v4
    s_mov_b64 exec, s[90:91]
    v_pk_fma_f32 v[136:137], v[136:137], v[240:241], v[232:233]
    v_pk_fma_f32 v[138:139], v[138:139], v[242:243], v[234:235]
    v_pk_fma_f32 v[140:141], v[140:141], v[244:245], v[236:237]
    v_pk_fma_f32 v[142:143], v[142:143], v[246:247], v[238:239]
    v_cvt_pk_bf16_f32 v136, v136, v137
    v_cvt_pk_bf16_f32 v137, v138, v139
    v_cvt_pk_bf16_f32 v138, v140, v141
    v_cvt_pk_bf16_f32 v139, v142, v143
    ds_write_b128 v11, v[136:139] offset:0
    v_pk_fma_f32 v[144:145], v[144:145], v[240:241], v[232:233]
    v_pk_fma_f32 v[146:147], v[146:147], v[242:243], v[234:235]
    v_pk_fma_f32 v[148:149], v[148:149], v[244:245], v[236:237]
    v_pk_fma_f32 v[150:151], v[150:151], v[246:247], v[238:239]
    v_cvt_pk_bf16_f32 v144, v144, v145
    v_cvt_pk_bf16_f32 v145, v146, v147
    v_cvt_pk_bf16_f32 v146, v148, v149
    v_cvt_pk_bf16_f32 v147, v150, v151
    ds_write_b128 v11, v[144:147] offset:928
    v_pk_fma_f32 v[152:153], v[152:153], v[240:241], v[232:233]
    v_pk_fma_f32 v[154:155], v[154:155], v[242:243], v[234:235]
    v_pk_fma_f32 v[156:157], v[156:157], v[244:245], v[236:237]
    v_pk_fma_f32 v[158:159], v[158:159], v[246:247], v[238:239]
    v_cvt_pk_bf16_f32 v152, v152, v153
    v_cvt_pk_bf16_f32 v153, v154, v155
    v_cvt_pk_bf16_f32 v154, v156, v157
    v_cvt_pk_bf16_f32 v155, v158, v159
    ds_write_b128 v11, v[152:155] offset:1856
    v_pk_fma_f32 v[160:161], v[160:161], v[240:241], v[232:233]
    v_pk_fma_f32 v[162:163], v[162:163], v[242:243], v[234:235]
    v_pk_fma_f32 v[164:165], v[164:165], v[244:245], v[236:237]
    v_pk_fma_f32 v[166:167], v[166:167], v[246:247], v[238:239]
    v_cvt_pk_bf16_f32 v160, v160, v161
    v_cvt_pk_bf16_f32 v161, v162, v163
    v_cvt_pk_bf16_f32 v162, v164, v165
    v_cvt_pk_bf16_f32 v163, v166, v167
    ds_write_b128 v11, v[160:163] offset:2784
    v_pk_fma_f32 v[168:169], v[168:169], v[240:241], v[232:233]
    v_pk_fma_f32 v[170:171], v[170:171], v[242:243], v[234:235]
    v_pk_fma_f32 v[172:173], v[172:173], v[244:245], v[236:237]
    v_pk_fma_f32 v[174:175], v[174:175], v[246:247], v[238:239]
    v_cvt_pk_bf16_f32 v168, v168, v169
    v_cvt_pk_bf16_f32 v169, v170, v171
    v_cvt_pk_bf16_f32 v170, v172, v173
    v_cvt_pk_bf16_f32 v171, v174, v175
    ds_write_b128 v11, v[168:171] offset:3712
    v_pk_fma_f32 v[176:177], v[176:177], v[240:241], v[232:233]
    v_pk_fma_f32 v[178:179], v[178:179], v[242:243], v[234:235]
    v_pk_fma_f32 v[180:181], v[180:181], v[244:245], v[236:237]
    v_pk_fma_f32 v[182:183], v[182:183], v[246:247], v[238:239]
    v_cvt_pk_bf16_f32 v176, v176, v177
    v_cvt_pk_bf16_f32 v177, v178, v179
    v_cvt_pk_bf16_f32 v178, v180, v181
    v_cvt_pk_bf16_f32 v179, v182, v183
    ds_write_b128 v11, v[176:179] offset:4640
    v_pk_fma_f32 v[184:185], v[184:185], v[240:241], v[232:233]
    v_pk_fma_f32 v[186:187], v[186:187], v[242:243], v[234:235]
    v_pk_fma_f32 v[188:189], v[188:189], v[244:245], v[236:237]
    v_pk_fma_f32 v[190:191], v[190:191], v[246:247], v[238:239]
    v_cvt_pk_bf16_f32 v184, v184, v185
    v_cvt_pk_bf16_f32 v185, v186, v187
    v_cvt_pk_bf16_f32 v186, v188, v189
    v_cvt_pk_bf16_f32 v187, v190, v191
    ds_write_b128 v11, v[184:187] offset:5568
    v_pk_fma_f32 v[192:193], v[192:193], v[240:241], v[232:233]
    v_pk_fma_f32 v[194:195], v[194:195], v[242:243], v[234:235]
    v_pk_fma_f32 v[196:197], v[196:197], v[244:245], v[236:237]
    v_pk_fma_f32 v[198:199], v[198:199], v[246:247], v[238:239]
    v_cvt_pk_bf16_f32 v192, v192, v193
    v_cvt_pk_bf16_f32 v193, v194, v195
    v_cvt_pk_bf16_f32 v194, v196, v197
    v_cvt_pk_bf16_f32 v195, v198, v199
    ds_write_b128 v11, v[192:195] offset:6496
    v_pk_fma_f32 v[200:201], v[200:201], v[240:241], v[232:233]
    v_pk_fma_f32 v[202:203], v[202:203], v[242:243], v[234:235]
    v_pk_fma_f32 v[204:205], v[204:205], v[244:245], v[236:237]
    v_pk_fma_f32 v[206:207], v[206:207], v[246:247], v[238:239]
    v_cvt_pk_bf16_f32 v200, v200, v201
    v_cvt_pk_bf16_f32 v201, v202, v203
    v_cvt_pk_bf16_f32 v202, v204, v205
    v_cvt_pk_bf16_f32 v203, v206, v207
    ds_write_b128 v11, v[200:203] offset:7424
    v_pk_fma_f32 v[208:209], v[208:209], v[240:241], v[232:233]
    v_pk_fma_f32 v[210:211], v[210:211], v[242:243], v[234:235]
    v_pk_fma_f32 v[212:213], v[212:213], v[244:245], v[236:237]
    v_pk_fma_f32 v[214:215], v[214:215], v[246:247], v[238:239]
    v_cvt_pk_bf16_f32 v208, v208, v209
    v_cvt_pk_bf16_f32 v209, v210, v211
    v_cvt_pk_bf16_f32 v210, v212, v213
    v_cvt_pk_bf16_f32 v211, v214, v215
    ds_write_b128 v11, v[208:211] offset:8352
    s_mov_b64 exec, -1
    s_cmp_lg_u32 s70, 0
    s_cbranch_scc1 ntch_10
    s_mul_i32 s72, s2, 0x680
    v_min_u32 v249, 12, v1
    v_lshlrev_b32 v249, 7, v249
    buffer_load_dword v248, v249, s[36:39], s72 offen
ntch_10:
    s_cmp_lg_u32 s70, 0
    s_cbranch_scc1 ntch_11
    s_mul_i32 s72, s2, 0x1880
    v_min_u32 v249, 48, v1
    v_lshlrev_b32 v249, 7, v249
    buffer_load_dword v248, v249, s[40:43], s72 offen
ntch_11:
    s_cmp_lg_u32 s70, 3
    s_cbranch_scc1 nfw_12
    s_cmp_gt_u32 s69, 3
    s_cbranch_scc1 nfw_12
    s_lshl_b32 s72, s68, 7
    s_lshl_b32 s73, s69, 12
    s_add_u32 s72, s72, s73
    s_add_u32 s72, s72, 0x4000
    v_mov_b32 v249, 0
    buffer_load_dword v248, v249, s[60:63], s72 offen sc1
nfw_12:
    s_branch L_gdone
L_g1:
    s_nop 2
    s_waitcnt vmcnt(0)
    s_mov_b32 s75, 0x3f803f80
    v_dot2_f32_bf16 v216, v176, s75, 0
    v_dot2_f32_bf16 v228, v176, v176, 0
    v_dot2_f32_bf16 v216, v177, s75, v216
    v_dot2_f32_bf16 v228, v177, v177, v228
    v_dot2_f32_bf16 v216, v178, s75, v216
    v_dot2_f32_bf16 v228, v178, v178, v228
    v_dot2_f32_bf16 v216, v179, s75, v216
    v_dot2_f32_bf16 v228, v179, v179, v228
    v_dot2_f32_bf16 v217, v180, s75, 0
    v_dot2_f32_bf16 v229, v180, v180, 0
    v_dot2_f32_bf16 v217, v181, s75, v217
    v_dot2_f32_bf16 v229, v181, v181, v229
    v_dot2_f32_bf16 v217, v182, s75, v217
    v_dot2_f32_bf16 v229, v182, v182, v229
    v_dot2_f32_bf16 v217, v183, s75, v217
    v_dot2_f32_bf16 v229, v183, v183, v229
    v_dot2_f32_bf16 v218, v184, s75, 0
    v_dot2_f32_bf16 v230, v184, v184, 0
    v_dot2_f32_bf16 v218, v185, s75, v218
    v_dot2_f32_bf16 v230, v185, v185, v230
    v_dot2_f32_bf16 v218, v186, s75, v218
    v_dot2_f32_bf16 v230, v186, v186, v230
    v_dot2_f32_bf16 v218, v187, s75, v218
    v_dot2_f32_bf16 v230, v187, v187, v230
    v_dot2_f32_bf16 v219, v188, s75, 0
    v_dot2_f32_bf16 v231, v188, v188, 0
    v_dot2_f32_bf16 v219, v189, s75, v219
    v_dot2_f32_bf16 v231, v189, v189, v231
    v_dot2_f32_bf16 v219, v190, s75, v219
    v_dot2_f32_bf16 v231, v190, v190, v231
    v_dot2_f32_bf16 v219, v191, s75, v219
    v_dot2_f32_bf16 v231, v191, v191, v231
    v_dot2_f32_bf16 v220, v192, s75, 0
    v_dot2_f32_bf16 v232, v192, v192, 0
    v_dot2_f32_bf16 v220, v193, s75, v220
    v_dot2_f32_bf16 v232, v193, v193, v232
    v_dot2_f32_bf16 v220, v194, s75, v220
    v_dot2_f32_bf16 v232, v194, v194, v232
    v_dot2_f32_bf16 v220, v195, s75, v220
    v_dot2_f32_bf16 v232, v195, v195, v232
    v_dot2_f32_bf16 v221, v196, s75, 0
    v_dot2_f32_bf16 v233, v196, v196, 0
    v_dot2_f32_bf16 v221, v197, s75, v221
    v_dot2_f32_bf16 v233, v197, v197, v233
    v_dot2_f32_bf16 v221, v198, s75, v221
    v_dot2_f32_bf16 v233, v198, v198, v233
    v_dot2_f32_bf16 v221, v199, s75, v221
    v_dot2_f32_bf16 v233, v199, v199, v233
    v_dot2_f32_bf16 v222, v200, s75, 0
    v_dot2_f32_bf16 v234, v200, v200, 0
    v_dot2_f32_bf16 v222, v201, s75, v222
    v_dot2_f32_bf16 v234, v201, v201, v234
    v_dot2_f32_bf16 v222, v202, s75, v222
    v_dot2_f32_bf16 v234, v202, v202, v234
    v_dot2_f32_bf16 v222, v203, s75, v222
    v_dot2_f32_bf16 v234, v203, v203, v234
    v_dot2_f32_bf16 v223, v204, s75, 0
    v_dot2_f32_bf16 v235, v204, v204, 0
    v_dot2_f32_bf16 v223, v205, s75, v223
    v_dot2_f32_bf16 v235, v205, v205, v235
    v_dot2_f32_bf16 v223, v206, s75, v223
    v_dot2_f32_bf16 v235, v206, v206, v235
    v_dot2_f32_bf16 v223, v207, s75, v223
    v_dot2_f32_bf16 v235, v207, v207, v235
    v_dot2_f32_bf16 v224, v208, s75, 0
    v_dot2_f32_bf16 v236, v208, v208, 0
    v_dot2_f32_bf16 v224, v209, s75, v224
    v_dot2_f32_bf16 v236, v209, v209, v236
    v_dot2_f32_bf16 v224, v210, s75, v224
    v_dot2_f32_bf16 v236, v210, v210, v236
    v_dot2_f32_bf16 v224, v211, s75, v224
    v_dot2_f32_bf16 v236, v211, v211, v236
    v_dot2_f32_bf16 v225, v212, s75, 0
    v_dot2_f32_bf16 v237, v212, v212, 0
    v_dot2_f32_bf16 v225, v213, s75, v225
    v_dot2_f32_bf16 v237, v213, v213, v237
    v_dot2_f32_bf16 v225, v214, s75, v225
    v_dot2_f32_bf16 v237, v214, v214, v237
    v_dot2_f32_bf16 v225, v215, s75, v225
    v_dot2_f32_bf16 v237, v215, v215, v237
    v_mov_b32 v226, 0
    v_mov_b32 v238, 0
    v_mov_b32 v227, 0
    v_mov_b32 v239, 0
    v_permlane32_swap_b32 v216, v218
    v_permlane32_swap_b32 v217, v219
    v_add_f32 v216, v216, v218
    v_add_f32 v217, v217, v219
    s_nop 1
    v_permlane16_swap_b32 v216, v217
    v_add_f32 v216, v216, v217
    s_nop 1
    v_add_f32_dpp v216, v216, v216 row_ror:8 row_mask:0xf bank_mask:0xf
    s_nop 1
    v_add_f32_dpp v216, v216, v216 row_ror:4 row_mask:0xf bank_mask:0xf
    s_nop 1
    v_add_f32_dpp v216, v216, v216 row_ror:2 row_mask:0xf bank_mask:0xf
    s_nop 1
    v_add_f32_dpp v216, v216, v216 row_ror:1 row_mask:0xf bank_mask:0xf
    v_permlane32_swap_b32 v228, v230
    v_permlane32_swap_b32 v229, v231
    v_add_f32 v228, v228, v230
    v_add_f32 v229, v229, v231
    s_nop 1
    v_permlane16_swap_b32 v228, v229
    v_add_f32 v228, v228, v229
    s_nop 1
    v_add_f32_dpp v228, v228, v228 row_ror:8 row_mask:0xf bank_mask:0xf
    s_nop 1
    v_add_f32_dpp v228, v228, v228 row_ror:4 row_mask:0xf bank_mask:0xf
    s_nop 1
    v_add_f32_dpp v228, v228, v228 row_ror:2 row_mask:0xf bank_mask:0xf
    s_nop 1
    v_add_f32_dpp v228, v228, v228 row_ror:1 row_mask:0xf bank_mask:0xf
    v_permlane32_swap_b32 v220, v222
    v_permlane32_swap_b32 v221, v223
    v_add_f32 v220, v220, v222
    v_add_f32 v221, v221, v223
    s_nop 1
    v_permlane16_swap_b32 v220, v221
    v_add_f32 v220, v220, v221
    s_nop 1
    v_add_f32_dpp v220, v220, v220 row_ror:8 row_mask:0xf bank_mask:0xf
    s_nop 1
    v_add_f32_dpp v220, v220, v220 row_ror:4 row_mask:0xf bank_mask:0xf
    s_nop 1
    v_add_f32_dpp v220, v220, v220 row_ror:2 row_mask:0xf bank_mask:0xf
    s_nop 1
    v_add_f32_dpp v220, v220, v220 row_ror:1 row_mask:0xf bank_mask:0xf
    v_permlane32_swap_b32 v232, v234
    v_permlane32_swap_b32 v233, v235
    v_add_f32 v232, v232, v234
    v_add_f32 v233, v233, v235
    s_nop 1
    v_permlane16_swap_b32 v232, v233
    v_add_f32 v232, v232, v233
    s_nop 1
    v_add_f32_dpp v232, v232, v232 row_ror:8 row_mask:0xf bank_mask:0xf
    s_nop 1
    v_add_f32_dpp v232, v232, v232 row_ror:4 row_mask:0xf bank_mask:0xf
    s_nop 1
    v_add_f32_dpp v232, v232, v232 row_ror:2 row_mask:0xf bank_mask:0xf
    s_nop 1
    v_add_f32_dpp v232, v232, v232 row_ror:1 row_mask:0xf bank_mask:0xf
    v_permlane32_swap_b32 v224, v226
    v_permlane32_swap_b32 v225, v227
    v_add_f32 v224, v224, v226
    v_add_f32 v225, v225, v227
    s_nop 1
    v_permlane16_swap_b32 v224, v225
    v_add_f32 v224, v224, v225
    s_nop 1
    v_add_f32_dpp v224, v224, v224 row_ror:8 row_mask:0xf bank_mask:0xf
    s_nop 1
    v_add_f32_dpp v224, v224, v224 row_ror:4 row_mask:0xf bank_mask:0xf
    s_nop 1
    v_add_f32_dpp v224, v224, v224 row_ror:2 row_mask:0xf bank_mask:0xf
    s_nop 1
    v_add_f32_dpp v224, v224, v224 row_ror:1 row_mask:0xf bank_mask:0xf
    v_permlane32_swap_b32 v236, v238
    v_permlane32_swap_b32 v237, v239
    v_add_f32 v236, v236, v238
    v_add_f32 v237, v237, v239
    s_nop 1
    v_permlane16_swap_b32 v236, v237
    v_add_f32 v236, v236, v237
    s_nop 1
    v_add_f32_dpp v236, v236, v236 row_ror:8 row_mask:0xf bank_mask:0xf
    s_nop 1
    v_add_f32_dpp v236, v236, v236 row_ror:4 row_mask:0xf bank_mask:0xf
    s_nop 1
    v_add_f32_dpp v236, v236, v236 row_ror:2 row_mask:0xf bank_mask:0xf
    s_nop 1
    v_add_f32_dpp v236, v236, v236 row_ror:1 row_mask:0xf bank_mask:0xf
    v_cmp_eq_u32 s[92:93], 1, v2
    v_cmp_eq_u32 s[94:95], 2, v2
    s_nop 0
    v_cndmask_b32 v216, v216, v220, s[92:93]
    v_cndmask_b32 v216, v216, v224, s[94:95]
    v_cndmask_b32 v228, v228, v232, s[92:93]
    v_cndmask_b32 v228, v228, v236, s[94:95]
    v_mul_f32 v216, 0x3b124925, v216
    v_mul_f32 v228, 0x3b124925, v228
    v_fma_f32 v228, -v216, v216, v228
    v_max_f32 v228, 0, v228
    v_cvt_pk_bf16_f32 v12, v216, v228
    v_lshlrev_b32 v10, 16, v12
    v_and_b32 v11, 0xffff0000, v12
    v_add_f32 v11, 0x3727c5ac, v11
    v_cvt_pk_bf16_f32 v12, v11, v11
    v_lshlrev_b32 v11, 16, v12
    v_sqrt_f32 v11, v11
    s_nop 0
    v_cvt_pk_bf16_f32 v12, v11, v11
    v_lshlrev_b32 v11, 16, v12
    v_rcp_f32 v216, v11
    s_nop 0
    v_mul_f32 v228, -v10, v216
    v_readlane_b32 s4, v216, 0
    v_readlane_b32 s5, v228, 0
    v_readlane_b32 s6, v216, 16
    v_readlane_b32 s7, v228, 16
    v_readlane_b32 s8, v216, 32
    v_readlane_b32 s9, v228, 32
    v_readlane_b32 s10, v216, 48
    v_readlane_b32 s11, v228, 48
    v_readlane_b32 s12, v216, 1
    v_readlane_b32 s13, v228, 1
    v_readlane_b32 s14, v216, 17
    v_readlane_b32 s15, v228, 17
    v_readlane_b32 s16, v216, 33
    v_readlane_b32 s17, v228, 33
    v_readlane_b32 s18, v216, 49
    v_readlane_b32 s19, v228, 49
    v_readlane_b32 s20, v216, 2
    v_readlane_b32 s21, v228, 2
    v_readlane_b32 s22, v216, 18
    v_readlane_b32 s23, v228, 18
    v_mov_b32 v14, s5
    v_lshlrev_b32 v136, 16, v176
    v_and_b32 v137, 0xffff0000, v176
    v_lshlrev_b32 v138, 16, v177
    v_and_b32 v139, 0xffff0000, v177
    v_lshlrev_b32 v140, 16, v178
    v_and_b32 v141, 0xffff0000, v178
    v_lshlrev_b32 v142, 16, v179
    v_and_b32 v143, 0xffff0000, v179
    v_pk_fma_f32 v[136:137], v[136:137], s[4:5], v[14:15] op_sel_hi:[1,0,0]
    v_pk_fma_f32 v[138:139], v[138:139], s[4:5], v[14:15] op_sel_hi:[1,0,0]
    v_pk_fma_f32 v[140:141], v[140:141], s[4:5], v[14:15] op_sel_hi:[1,0,0]
    v_pk_fma_f32 v[142:143], v[142:143], s[4:5], v[14:15] op_sel_hi:[1,0,0]
    v_mov_b32 v14, s7
    v_lshlrev_b32 v144, 16, v180
    v_and_b32 v145, 0xffff0000, v180
    v_lshlrev_b32 v146, 16, v181
    v_and_b32 v147, 0xffff0000, v181
    v_lshlrev_b32 v148, 16, v182
    v_and_b32 v149, 0xffff0000, v182
    v_lshlrev_b32 v150, 16, v183
    v_and_b32 v151, 0xffff0000, v183
    v_pk_fma_f32 v[144:145], v[144:145], s[6:7], v[14:15] op_sel_hi:[1,0,0]
    v_pk_fma_f32 v[146:147], v[146:147], s[6:7], v[14:15] op_sel_hi:[1,0,0]
    v_pk_fma_f32 v[148:149], v[148:149], s[6:7], v[14:15] op_sel_hi:[1,0,0]
    v_pk_fma_f32 v[150:151], v[150:151], s[6:7], v[14:15] op_sel_hi:[1,0,0]
    v_mov_b32 v14, s9
    v_lshlrev_b32 v152, 16, v184
    v_and_b32 v153, 0xffff0000, v184
    v_lshlrev_b32 v154, 16, v185
    v_and_b32 v155, 0xffff0000, v185
    v_lshlrev_b32 v156, 16, v186
    v_and_b32 v157, 0xffff0000, v186
    v_lshlrev_b32 v158, 16, v187
    v_and_b32 v159, 0xffff0000, v187
    v_pk_fma_f32 v[152:153], v[152:153], s[8:9], v[14:15] op_sel_hi:[1,0,0]
    v_pk_fma_f32 v[154:155], v[154:155], s[8:9], v[14:15] op_sel_hi:[1,0,0]
    v_pk_fma_f32 v[156:157], v[156:157], s[8:9], v[14:15] op_sel_hi:[1,0,0]
    v_pk_fma_f32 v[158:159], v[158:159], s[8:9], v[14:15] op_sel_hi:[1,0,0]
    v_mov_b32 v14, s11
    v_lshlrev_b32 v160, 16, v188
    v_and_b32 v161, 0xffff0000, v188
    v_lshlrev_b32 v162, 16, v189
    v_and_b32 v163, 0xffff0000, v189
    v_lshlrev_b32 v164, 16, v190
    v_and_b32 v165, 0xffff0000, v190
    v_lshlrev_b32 v166, 16, v191
    v_and_b32 v167, 0xffff0000, v191
    v_pk_fma_f32 v[160:161], v[160:161], s[10:11], v[14:15] op_sel_hi:[1,0,0]
    v_pk_fma_f32 v[162:163], v[162:163], s[10:11], v[14:15] op_sel_hi:[1,0,0]
    v_pk_fma_f32 v[164:165], v[164:165], s[10:11], v[14:15] op_sel_hi:[1,0,0]
    v_pk_fma_f32 v[166:167], v[166:167], s[10:11], v[14:15] op_sel_hi:[1,0,0]
    v_mov_b32 v14, s13
    v_lshlrev_b32 v168, 16, v192
    v_and_b32 v169, 0xffff0000, v192
    v_lshlrev_b32 v170, 16, v193
    v_and_b32 v171, 0xffff0000, v193
    v_lshlrev_b32 v172, 16, v194
    v_and_b32 v173, 0xffff0000, v194
    v_lshlrev_b32 v174, 16, v195
    v_and_b32 v175, 0xffff0000, v195
    v_pk_fma_f32 v[168:169], v[168:169], s[12:13], v[14:15] op_sel_hi:[1,0,0]
    v_pk_fma_f32 v[170:171], v[170:171], s[12:13], v[14:15] op_sel_hi:[1,0,0]
    v_pk_fma_f32 v[172:173], v[172:173], s[12:13], v[14:15] op_sel_hi:[1,0,0]
    v_pk_fma_f32 v[174:175], v[174:175], s[12:13], v[14:15] op_sel_hi:[1,0,0]
    v_mov_b32 v14, s15
    v_lshlrev_b32 v176, 16, v196
    v_and_b32 v177, 0xffff0000, v196
    v_lshlrev_b32 v178, 16, v197
    v_and_b32 v179, 0xffff0000, v197
    v_lshlrev_b32 v180, 16, v198
    v_and_b32 v181, 0xffff0000, v198
    v_lshlrev_b32 v182, 16, v199
    v_and_b32 v183, 0xffff0000, v199
    v_pk_fma_f32 v[176:177], v[176:177], s[14:15], v[14:15] op_sel_hi:[1,0,0]
    v_pk_fma_f32 v[178:179], v[178:179], s[14:15], v[14:15] op_sel_hi:[1,0,0]
    v_pk_fma_f32 v[180:181], v[180:181], s[14:15], v[14:15] op_sel_hi:[1,0,0]
    v_pk_fma_f32 v[182:183], v[182:183], s[14:15], v[14:15] op_sel_hi:[1,0,0]
    v_mov_b32 v14, s17
    v_lshlrev_b32 v184, 16, v200
    v_and_b32 v185, 0xffff0000, v200
    v_lshlrev_b32 v186, 16, v201
    v_and_b32 v187, 0xffff0000, v201
    v_lshlrev_b32 v188, 16, v202
    v_and_b32 v189, 0xffff0000, v202
    v_lshlrev_b32 v190, 16, v203
    v_and_b32 v191, 0xffff0000, v203
    v_pk_fma_f32 v[184:185], v[184:185], s[16:17], v[14:15] op_sel_hi:[1,0,0]
    v_pk_fma_f32 v[186:187], v[186:187], s[16:17], v[14:15] op_sel_hi:[1,0,0]
    v_pk_fma_f32 v[188:189], v[188:189], s[16:17], v[14:15] op_sel_hi:[1,0,0]
    v_pk_fma_f32 v[190:191], v[190:191], s[16:17], v[14:15] op_sel_hi:[1,0,0]
    v_mov_b32 v14, s19
    v_lshlrev_b32 v192, 16, v204
    v_and_b32 v193, 0xffff0000, v204
    v_lshlrev_b32 v194, 16, v205
    v_and_b32 v195, 0xffff0000, v205
    v_lshlrev_b32 v196, 16, v206
    v_and_b32 v197, 0xffff0000, v206
    v_lshlrev_b32 v198, 16, v207
    v_and_b32 v199, 0xffff0000, v207
    v_pk_fma_f32 v[192:193], v[192:193], s[18:19], v[14:15] op_sel_hi:[1,0,0]
    v_pk_fma_f32 v[194:195], v[194:195], s[18:19], v[14:15] op_sel_hi:[1,0,0]
    v_pk_fma_f32 v[196:197], v[196:197], s[18:19], v[14:15] op_sel_hi:[1,0,0]
    v_pk_fma_f32 v[198:199], v[198:199], s[18:19], v[14:15] op_sel_hi:[1,0,0]
    v_mov_b32 v14, s21
    v_lshlrev_b32 v200, 16, v208
    v_and_b32 v201, 0xffff0000, v208
    v_lshlrev_b32 v202, 16, v209
    v_and_b32 v203, 0xffff0000, v209
    v_lshlrev_b32 v204, 16, v210
    v_and_b32 v205, 0xffff0000, v210
    v_lshlrev_b32 v206, 16, v211
    v_and_b32 v207, 0xffff0000, v211
    v_pk_fma_f32 v[200:201], v[200:201], s[20:21], v[14:15] op_sel_hi:[1,0,0]
    v_pk_fma_f32 v[202:203], v[202:203], s[20:21], v[14:15] op_sel_hi:[1,0,0]
    v_pk_fma_f32 v[204:205], v[204:205], s[20:21], v[14:15] op_sel_hi:[1,0,0]
    v_pk_fma_f32 v[206:207], v[206:207], s[20:21], v[14:15] op_sel_hi:[1,0,0]
    s_cmp_lg_u32 s70, 7
    s_cbranch_scc1 L_g7i
    v_mov_b32 v247, 0
    buffer_load_dword v247, v247, s[64:67], 0 offen sc1
    s_mov_b32 s72, 0
    buffer_load_dwordx4 v[216:219], v255, s[60:63], s72 offen sc1
    buffer_load_dwordx4 v[220:223], v255, s[60:63], s72 offen offset:16 sc1
    s_mov_b32 s72, 0x700
    buffer_load_dwordx4 v[224:227], v255, s[60:63], s72 offen sc1
    buffer_load_dwordx4 v[228:231], v255, s[60:63], s72 offen offset:16 sc1
L_g7i:
    v_mov_b32 v14, s23
    v_mov_b32 v10, v212
    v_mov_b32 v11, v213
    v_mov_b32 v12, v214
    v_mov_b32 v13, v215
    v_lshlrev_b32 v208, 16, v10
    v_and_b32 v209, 0xffff0000, v10
    v_lshlrev_b32 v210, 16, v11
    v_and_b32 v211, 0xffff0000, v11
    v_lshlrev_b32 v212, 16, v12
    v_and_b32 v213, 0xffff0000, v12
    v_lshlrev_b32 v214, 16, v13
    v_and_b32 v215, 0xffff0000, v13
    v_pk_fma_f32 v[208:209], v[208:209], s[22:23], v[14:15] op_sel_hi:[1,0,0]
    v_pk_fma_f32 v[210:211], v[210:211], s[22:23], v[14:15] op_sel_hi:[1,0,0]
    v_pk_fma_f32 v[212:213], v[212:213], s[22:23], v[14:15] op_sel_hi:[1,0,0]
    v_pk_fma_f32 v[214:215], v[214:215], s[22:23], v[14:15] op_sel_hi:[1,0,0]
    s_cmp_lg_u32 s70, 7
    s_cbranch_scc1 L_g1b
    s_mov_b32 s101, 0
lw_13:
    ds_read_b128 v[16:19], v8 offset:224
    s_add_u32 s101, s101, 1
    s_cmp_gt_u32 s101, 0x3d0900
    s_cbranch_scc1 lwd_14
    s_waitcnt lgkmcnt(0)
    v_min_u32 v18, v18, v19
    v_min3_u32 v18, v18, v16, v17
    s_nop 0
    v_readfirstlane_b32 s79, v18
    s_nop 0
    s_cmp_ge_u32 s79, 1
    s_cbranch_scc1 lwd_14
    s_branch lw_13
lwd_14:
    s_nop 0
    ds_read_b64_tr_b16 v[20:21], v250 offset:0
    ds_read_b64_tr_b16 v[22:23], v250 offset:512
    ds_read_b64_tr_b16 v[24:25], v251 offset:0
    ds_read_b64_tr_b16 v[26:27], v251 offset:512
    ds_read_b64_tr_b16 v[28:29], v250 offset:12288
    ds_read_b64_tr_b16 v[30:31], v250 offset:12800
    ds_read_b64_tr_b16 v[32:33], v251 offset:12288
    ds_read_b64_tr_b16 v[34:35], v251 offset:12800
    ds_read_b64_tr_b16 v[36:37], v250 offset:24576
    ds_read_b64_tr_b16 v[38:39], v250 offset:25088
    ds_read_b64_tr_b16 v[40:41], v251 offset:24576
    ds_read_b64_tr_b16 v[42:43], v251 offset:25088
    s_waitcnt lgkmcnt(11)
    ds_read_b64_tr_b16 v[44:45], v250 offset:36864
    ds_read_b64_tr_b16 v[46:47], v250 offset:37376
    ds_read_b64_tr_b16 v[48:49], v251 offset:36864
    ds_read_b64_tr_b16 v[50:51], v251 offset:37376
    s_waitcnt lgkmcnt(11)
    ds_read_b64_tr_b16 v[52:53], v250 offset:49152
    ds_read_b64_tr_b16 v[54:55], v250 offset:49664
    ds_read_b64_tr_b16 v[56:57], v251 offset:49152
    ds_read_b64_tr_b16 v[58:59], v251 offset:49664
    s_waitcnt lgkmcnt(11)
    ds_read_b64_tr_b16 v[60:61], v250 offset:61440
    ds_read_b64_tr_b16 v[62:63], v250 offset:61952
    ds_read_b64_tr_b16 v[64:65], v251 offset:61440
    ds_read_b64_tr_b16 v[66:67], v251 offset:61952
    s_waitcnt lgkmcnt(14)
    v_mov_b32 v19, 1
    s_mov_b64 exec, 1
    ds_add_u32 v8, v19 offset:20
    s_mov_b64 exec, -1
    s_waitcnt vmcnt(0)
    v_readfirstlane_b32 s71, v247
    s_nop 0
    s_max_u32 s73, s71, 1
    v_xor_b32 v18, s71, v217
    v_xor_b32 v19, s71, v219
    v_or_b32 v18, v18, v19
    v_xor_b32 v19, s71, v221
    v_or_b32 v18, v18, v19
    v_xor_b32 v19, s71, v223
    v_or_b32 v18, v18, v19
    v_xor_b32 v19, s71, v225
    v_or_b32 v18, v18, v19
    v_xor_b32 v19, s71, v227
    v_or_b32 v18, v18, v19
    v_xor_b32 v19, s71, v229
    v_or_b32 v18, v18, v19
    v_xor_b32 v19, s71, v231
    v_or_b32 v18, v18, v19
    s_xor_b32 s73, s73, s71
    v_or_b32 v18, s73, v18
    v_cmp_ne_u32 vcc, 0, v18
    s_cbranch_vccz gok_15
    s_mov_b32 s101, 0
glp_16:
    v_mov_b32 v247, 0
    buffer_load_dword v247, v247, s[64:67], 0 offen sc1
    s_mov_b32 s72, 0
    buffer_load_dwordx4 v[216:219], v255, s[60:63], s72 offen sc1
    buffer_load_dwordx4 v[220:223], v255, s[60:63], s72 offen offset:16 sc1
    s_mov_b32 s72, 0x700
    buffer_load_dwordx4 v[224:227], v255, s[60:63], s72 offen sc1
    buffer_load_dwordx4 v[228:231], v255, s[60:63], s72 offen offset:16 sc1
    s_add_u32 s101, s101, 1
    s_cmp_gt_u32 s101, 0x61a80
    s_cbranch_scc1 gok_15
    s_waitcnt vmcnt(0)
    v_readfirstlane_b32 s71, v247
    s_nop 0
    s_max_u32 s73, s71, 1
    v_xor_b32 v18, s71, v217
    v_xor_b32 v19, s71, v219
    v_or_b32 v18, v18, v19
    v_xor_b32 v19, s71, v221
    v_or_b32 v18, v18, v19
    v_xor_b32 v19, s71, v223
    v_or_b32 v18, v18, v19
    v_xor_b32 v19, s71, v225
    v_or_b32 v18, v18, v19
    v_xor_b32 v19, s71, v227
    v_or_b32 v18, v18, v19
    v_xor_b32 v19, s71, v229
    v_or_b32 v18, v18, v19
    v_xor_b32 v19, s71, v231
    v_or_b32 v18, v18, v19
    s_xor_b32 s73, s73, s71
    v_or_b32 v18, s73, v18
    v_cmp_ne_u32 vcc, 0, v18
    s_cbranch_vccnz glp_16
gok_15:
    s_nop 3
    v_lshlrev_b32 v232, 16, v216
    v_and_b32 v233, 0xffff0000, v216
    v_lshlrev_b32 v234, 16, v218
    v_and_b32 v235, 0xffff0000, v218
    v_lshlrev_b32 v236, 16, v220
    v_and_b32 v237, 0xffff0000, v220
    v_lshlrev_b32 v238, 16, v222
    v_and_b32 v239, 0xffff0000, v222
    v_lshlrev_b32 v240, 16, v224
    v_and_b32 v241, 0xffff0000, v224
    v_lshlrev_b32 v242, 16, v226
    v_and_b32 v243, 0xffff0000, v226
    v_lshlrev_b32 v244, 16, v228
    v_and_b32 v245, 0xffff0000, v228
    v_lshlrev_b32 v246, 16, v230
    v_and_b32 v247, 0xffff0000, v230
    v_pk_add_f32 v[240:241], v[240:241], 1.0 op_sel_hi:[1,0]
    v_pk_add_f32 v[242:243], v[242:243], 1.0 op_sel_hi:[1,0]
    v_pk_add_f32 v[244:245], v[244:245], 1.0 op_sel_hi:[1,0]
    v_pk_add_f32 v[246:247], v[246:247], 1.0 op_sel_hi:[1,0]
    v_cvt_pk_bf16_f32 v18, v240, v241
    v_lshlrev_b32 v240, 16, v18
    v_and_b32 v241, 0xffff0000, v18
    v_cvt_pk_bf16_f32 v18, v242, v243
    v_lshlrev_b32 v242, 16, v18
    v_and_b32 v243, 0xffff0000, v18
    v_cvt_pk_bf16_f32 v18, v244, v245
    v_lshlrev_b32 v244, 16, v18
    v_and_b32 v245, 0xffff0000, v18
    v_cvt_pk_bf16_f32 v18, v246, v247
    v_lshlrev_b32 v246, 16, v18
    v_and_b32 v247, 0xffff0000, v18
    v_lshlrev_b32 v18, 6, v1
    v_add_u32 v18, 0x25800, v18
    s_waitcnt lgkmcnt(0)
    ds_write_b128 v18, v[232:235] offset:0
    ds_write_b128 v18, v[236:239] offset:16
    ds_write_b128 v18, v[240:243] offset:32
    ds_write_b128 v18, v[244:247] offset:48
    v_mov_b32 v18, 0x27220
    v_mov_b32 v19, s71
    ds_write_b32 v18, v19
    s_waitcnt lgkmcnt(0)
    s_mov_b32 s101, 0
lw_17:
    ds_read_b32 v18, v8 offset:20
    s_add_u32 s101, s101, 1
    s_cmp_gt_u32 s101, 0x3d0900
    s_cbranch_scc1 lwd_18
    s_waitcnt lgkmcnt(0)
    v_readfirstlane_b32 s79, v18
    s_nop 0
    s_cmp_ge_u32 s79, 8
    s_cbranch_scc1 lwd_18
    s_branch lw_17
lwd_18:
    s_nop 0
    s_mul_i32 s72, s89, 0x2440
    v_add_u32 v11, s72, v4
    s_mov_b64 exec, s[90:91]
    v_pk_fma_f32 v[136:137], v[136:137], v[240:241], v[232:233]
    v_pk_fma_f32 v[138:139], v[138:139], v[242:243], v[234:235]
    v_pk_fma_f32 v[140:141], v[140:141], v[244:245], v[236:237]
    v_pk_fma_f32 v[142:143], v[142:143], v[246:247], v[238:239]
    v_cvt_pk_bf16_f32 v136, v136, v137
    v_cvt_pk_bf16_f32 v137, v138, v139
    v_cvt_pk_bf16_f32 v138, v140, v141
    v_cvt_pk_bf16_f32 v139, v142, v143
    ds_write_b128 v11, v[136:139] offset:0
    v_pk_fma_f32 v[144:145], v[144:145], v[240:241], v[232:233]
    v_pk_fma_f32 v[146:147], v[146:147], v[242:243], v[234:235]
    v_pk_fma_f32 v[148:149], v[148:149], v[244:245], v[236:237]
    v_pk_fma_f32 v[150:151], v[150:151], v[246:247], v[238:239]
    v_cvt_pk_bf16_f32 v144, v144, v145
    v_cvt_pk_bf16_f32 v145, v146, v147
    v_cvt_pk_bf16_f32 v146, v148, v149
    v_cvt_pk_bf16_f32 v147, v150, v151
    ds_write_b128 v11, v[144:147] offset:928
    v_pk_fma_f32 v[152:153], v[152:153], v[240:241], v[232:233]
    v_pk_fma_f32 v[154:155], v[154:155], v[242:243], v[234:235]
    v_pk_fma_f32 v[156:157], v[156:157], v[244:245], v[236:237]
    v_pk_fma_f32 v[158:159], v[158:159], v[246:247], v[238:239]
    v_cvt_pk_bf16_f32 v152, v152, v153
    v_cvt_pk_bf16_f32 v153, v154, v155
    v_cvt_pk_bf16_f32 v154, v156, v157
    v_cvt_pk_bf16_f32 v155, v158, v159
    ds_write_b128 v11, v[152:155] offset:1856
    v_pk_fma_f32 v[160:161], v[160:161], v[240:241], v[232:233]
    v_pk_fma_f32 v[162:163], v[162:163], v[242:243], v[234:235]
    v_pk_fma_f32 v[164:165], v[164:165], v[244:245], v[236:237]
    v_pk_fma_f32 v[166:167], v[166:167], v[246:247], v[238:239]
    v_cvt_pk_bf16_f32 v160, v160, v161
    v_cvt_pk_bf16_f32 v161, v162, v163
    v_cvt_pk_bf16_f32 v162, v164, v165
    v_cvt_pk_bf16_f32 v163, v166, v167
    ds_write_b128 v11, v[160:163] offset:2784
    v_pk_fma_f32 v[168:169], v[168:169], v[240:241], v[232:233]
    v_pk_fma_f32 v[170:171], v[170:171], v[242:243], v[234:235]
    v_pk_fma_f32 v[172:173], v[172:173], v[244:245], v[236:237]
    v_pk_fma_f32 v[174:175], v[174:175], v[246:247], v[238:239]
    v_cvt_pk_bf16_f32 v168, v168, v169
    v_cvt_pk_bf16_f32 v169, v170, v171
    v_cvt_pk_bf16_f32 v170, v172, v173
    v_cvt_pk_bf16_f32 v171, v174, v175
    ds_write_b128 v11, v[168:171] offset:3712
    v_pk_fma_f32 v[176:177], v[176:177], v[240:241], v[232:233]
    v_pk_fma_f32 v[178:179], v[178:179], v[242:243], v[234:235]
    v_pk_fma_f32 v[180:181], v[180:181], v[244:245], v[236:237]
    v_pk_fma_f32 v[182:183], v[182:183], v[246:247], v[238:239]
    v_cvt_pk_bf16_f32 v176, v176, v177
    v_cvt_pk_bf16_f32 v177, v178, v179
    v_cvt_pk_bf16_f32 v178, v180, v181
    v_cvt_pk_bf16_f32 v179, v182, v183
    ds_write_b128 v11, v[176:179] offset:4640
    v_pk_fma_f32 v[184:185], v[184:185], v[240:241], v[232:233]
    v_pk_fma_f32 v[186:187], v[186:187], v[242:243], v[234:235]
    v_pk_fma_f32 v[188:189], v[188:189], v[244:245], v[236:237]
    v_pk_fma_f32 v[190:191], v[190:191], v[246:247], v[238:239]
    v_cvt_pk_bf16_f32 v184, v184, v185
    v_cvt_pk_bf16_f32 v185, v186, v187
    v_cvt_pk_bf16_f32 v186, v188, v189
    v_cvt_pk_bf16_f32 v187, v190, v191
    ds_write_b128 v11, v[184:187] offset:5568
    v_pk_fma_f32 v[192:193], v[192:193], v[240:241], v[232:233]
    v_pk_fma_f32 v[194:195], v[194:195], v[242:243], v[234:235]
    v_pk_fma_f32 v[196:197], v[196:197], v[244:245], v[236:237]
    v_pk_fma_f32 v[198:199], v[198:199], v[246:247], v[238:239]
    v_cvt_pk_bf16_f32 v192, v192, v193
    v_cvt_pk_bf16_f32 v193, v194, v195
    v_cvt_pk_bf16_f32 v194, v196, v197
    v_cvt_pk_bf16_f32 v195, v198, v199
    ds_write_b128 v11, v[192:195] offset:6496
    v_pk_fma_f32 v[200:201], v[200:201], v[240:241], v[232:233]
    v_pk_fma_f32 v[202:203], v[202:203], v[242:243], v[234:235]
    v_pk_fma_f32 v[204:205], v[204:205], v[244:245], v[236:237]
    v_pk_fma_f32 v[206:207], v[206:207], v[246:247], v[238:239]
    v_cvt_pk_bf16_f32 v200, v200, v201
    v_cvt_pk_bf16_f32 v201, v202, v203
    v_cvt_pk_bf16_f32 v202, v204, v205
    v_cvt_pk_bf16_f32 v203, v206, v207
    ds_write_b128 v11, v[200:203] offset:7424
    v_pk_fma_f32 v[208:209], v[208:209], v[240:241], v[232:233]
    v_pk_fma_f32 v[210:211], v[210:211], v[242:243], v[234:235]
    v_pk_fma_f32 v[212:213], v[212:213], v[244:245], v[236:237]
    v_pk_fma_f32 v[214:215], v[214:215], v[246:247], v[238:239]
    v_cvt_pk_bf16_f32 v208, v208, v209
    v_cvt_pk_bf16_f32 v209, v210, v211
    v_cvt_pk_bf16_f32 v210, v212, v213
    v_cvt_pk_bf16_f32 v211, v214, v215
    ds_write_b128 v11, v[208:211] offset:8352
    s_mov_b64 exec, -1
    s_add_u32 m0, s81, 0x12200
    s_nop 0
    buffer_load_dwordx4 v254, s[32:35], s82 offen lds
    s_add_u32 s82, s82, 0x380
    s_add_u32 m0, s81, 0x13200
    s_nop 0
    buffer_load_dwordx4 v254, s[32:35], s82 offen lds
    s_add_u32 s82, s82, 0x380
    s_add_u32 m0, s81, 0x14200
    s_nop 0
    buffer_load_dwordx4 v254, s[32:35], s82 offen lds
    s_add_u32 s82, s82, 0x14900
    s_add_u32 m0, s81, 0x15200
    s_nop 0
    buffer_load_dwordx4 v254, s[32:35], s82 offen lds
    s_add_u32 s82, s82, 0x380
    s_add_u32 m0, s81, 0x16200
    s_nop 0
    buffer_load_dwordx4 v254, s[32:35], s82 offen lds
    s_add_u32 s82, s82, 0x380
    s_add_u32 m0, s81, 0x17200
    s_nop 0
    buffer_load_dwordx4 v254, s[32:35], s82 offen lds
    s_add_u32 s82, s82, 0x14900
    s_add_u32 m0, s81, 0x18200
    s_nop 0
    buffer_load_dwordx4 v254, s[32:35], s82 offen lds
    s_add_u32 s82, s82, 0x380
    s_add_u32 m0, s81, 0x19200
    s_nop 0
    buffer_load_dwordx4 v254, s[32:35], s82 offen lds
    s_add_u32 s82, s82, 0x380
    s_add_u32 m0, s81, 0x1a200
    s_nop 0
    buffer_load_dwordx4 v254, s[32:35], s82 offen lds
    s_add_u32 s82, s82, 0x14900
    s_add_u32 m0, s81, 0x1b200
    s_nop 0
    buffer_load_dwordx4 v254, s[32:35], s82 offen lds
    s_add_u32 s82, s82, 0x380
    s_add_u32 m0, s81, 0x1c200
    s_nop 0
    buffer_load_dwordx4 v254, s[32:35], s82 offen lds
    s_add_u32 s82, s82, 0x380
    s_add_u32 m0, s81, 0x1d200
    s_nop 0
    buffer_load_dwordx4 v254, s[32:35], s82 offen lds
    s_add_u32 s82, s82, 0x14900
    s_add_u32 m0, s81, 0x1e200
    s_nop 0
    buffer_load_dwordx4 v254, s[32:35], s82 offen lds
    s_add_u32 s82, s82, 0x380
    s_add_u32 m0, s81, 0x1f200
    s_nop 0
    buffer_load_dwordx4 v254, s[32:35], s82 offen lds
    s_add_u32 s82, s82, 0x380
    s_add_u32 m0, s81, 0x20200
    s_nop 0
    buffer_load_dwordx4 v254, s[32:35], s82 offen lds
    s_add_u32 s82, s82, 0x14900
    s_add_u32 m0, s81, 0x21200
    s_nop 0
    buffer_load_dwordx4 v254, s[32:35], s82 offen lds
    s_add_u32 s82, s82, 0x380
    s_add_u32 m0, s81, 0x22200
    s_nop 0
    buffer_load_dwordx4 v254, s[32:35], s82 offen lds
    s_add_u32 s82, s82, 0x380
    s_add_u32 m0, s81, 0x23200
    s_nop 0
    buffer_load_dwordx4 v254, s[32:35], s82 offen lds
    s_add_u32 s82, s82, 0x14900
    s_branch L_gdone
L_g1b:
    s_add_u32 m0, s81, 0x12200
    s_nop 0
    buffer_load_dwordx4 v254, s[32:35], s82 offen lds
    s_add_u32 s82, s82, 0x380
    s_add_u32 m0, s81, 0x13200
    s_nop 0
    buffer_load_dwordx4 v254, s[32:35], s82 offen lds
    s_add_u32 s82, s82, 0x380
    s_add_u32 m0, s81, 0x14200
    s_nop 0
    buffer_load_dwordx4 v254, s[32:35], s82 offen lds
    s_add_u32 s82, s82, 0x14900
    s_add_u32 m0, s81, 0x15200
    s_nop 0
    buffer_load_dwordx4 v254, s[32:35], s82 offen lds
    s_add_u32 s82, s82, 0x380
    s_add_u32 m0, s81, 0x16200
    s_nop 0
    buffer_load_dwordx4 v254, s[32:35], s82 offen lds
    s_add_u32 s82, s82, 0x380
    s_add_u32 m0, s81, 0x17200
    s_nop 0
    buffer_load_dwordx4 v254, s[32:35], s82 offen lds
    s_add_u32 s82, s82, 0x14900
    s_add_u32 m0, s81, 0x18200
    s_nop 0
    buffer_load_dwordx4 v254, s[32:35], s82 offen lds
    s_add_u32 s82, s82, 0x380
    s_add_u32 m0, s81, 0x19200
    s_nop 0
    buffer_load_dwordx4 v254, s[32:35], s82 offen lds
    s_add_u32 s82, s82, 0x380
    s_add_u32 m0, s81, 0x1a200
    s_nop 0
    buffer_load_dwordx4 v254, s[32:35], s82 offen lds
    s_add_u32 s82, s82, 0x14900
    s_add_u32 m0, s81, 0x1b200
    s_nop 0
    buffer_load_dwordx4 v254, s[32:35], s82 offen lds
    s_add_u32 s82, s82, 0x380
    s_add_u32 m0, s81, 0x1c200
    s_nop 0
    buffer_load_dwordx4 v254, s[32:35], s82 offen lds
    s_add_u32 s82, s82, 0x380
    s_add_u32 m0, s81, 0x1d200
    s_nop 0
    buffer_load_dwordx4 v254, s[32:35], s82 offen lds
    s_add_u32 s82, s82, 0x14900
    s_add_u32 m0, s81, 0x1e200
    s_nop 0
    buffer_load_dwordx4 v254, s[32:35], s82 offen lds
    s_add_u32 s82, s82, 0x380
    s_add_u32 m0, s81, 0x1f200
    s_nop 0
    buffer_load_dwordx4 v254, s[32:35], s82 offen lds
    s_add_u32 s82, s82, 0x380
    s_add_u32 m0, s81, 0x20200
    s_nop 0
    buffer_load_dwordx4 v254, s[32:35], s82 offen lds
    s_add_u32 s82, s82, 0x14900
    s_add_u32 m0, s81, 0x21200
    s_nop 0
    buffer_load_dwordx4 v254, s[32:35], s82 offen lds
    s_add_u32 s82, s82, 0x380
    s_add_u32 m0, s81, 0x22200
    s_nop 0
    buffer_load_dwordx4 v254, s[32:35], s82 offen lds
    s_add_u32 s82, s82, 0x380
    s_add_u32 m0, s81, 0x23200
    s_nop 0
    buffer_load_dwordx4 v254, s[32:35], s82 offen lds
    s_add_u32 s82, s82, 0x14900
    s_mov_b32 s101, 0
lw_19:
    ds_read_b128 v[16:19], v8 offset:224
    s_add_u32 s101, s101, 1
    s_cmp_gt_u32 s101, 0x3d0900
    s_cbranch_scc1 lwd_20
    s_waitcnt lgkmcnt(0)
    v_min_u32 v18, v18, v19
    v_min3_u32 v18, v18, v16, v17
    s_nop 0
    v_readfirstlane_b32 s79, v18
    s_nop 0
    s_cmp_ge_u32 s79, 1
    s_cbranch_scc1 lwd_20
    s_branch lw_19
lwd_20:
    s_nop 0
    ds_read_b64_tr_b16 v[20:21], v250 offset:0
    ds_read_b64_tr_b16 v[22:23], v250 offset:512
    ds_read_b64_tr_b16 v[24:25], v251 offset:0
    ds_read_b64_tr_b16 v[26:27], v251 offset:512
    ds_read_b64_tr_b16 v[28:29], v250 offset:12288
    ds_read_b64_tr_b16 v[30:31], v250 offset:12800
    ds_read_b64_tr_b16 v[32:33], v251 offset:12288
    ds_read_b64_tr_b16 v[34:35], v251 offset:12800
    ds_read_b64_tr_b16 v[36:37], v250 offset:24576
    ds_read_b64_tr_b16 v[38:39], v250 offset:25088
    ds_read_b64_tr_b16 v[40:41], v251 offset:24576
    ds_read_b64_tr_b16 v[42:43], v251 offset:25088
    s_waitcnt lgkmcnt(11)
    ds_read_b64_tr_b16 v[44:45], v250 offset:36864
    ds_read_b64_tr_b16 v[46:47], v250 offset:37376
    ds_read_b64_tr_b16 v[48:49], v251 offset:36864
    ds_read_b64_tr_b16 v[50:51], v251 offset:37376
    s_waitcnt lgkmcnt(11)
    ds_read_b64_tr_b16 v[52:53], v250 offset:49152
    ds_read_b64_tr_b16 v[54:55], v250 offset:49664
    ds_read_b64_tr_b16 v[56:57], v251 offset:49152
    ds_read_b64_tr_b16 v[58:59], v251 offset:49664
    s_waitcnt lgkmcnt(11)
    ds_read_b64_tr_b16 v[60:61], v250 offset:61440
    ds_read_b64_tr_b16 v[62:63], v250 offset:61952
    ds_read_b64_tr_b16 v[64:65], v251 offset:61440
    ds_read_b64_tr_b16 v[66:67], v251 offset:61952
    s_waitcnt lgkmcnt(14)
    v_mov_b32 v19, 1
    s_mov_b64 exec, 1
    ds_add_u32 v8, v19 offset:20
    s_mov_b64 exec, -1
    v_mov_b32 v18, 0x27220
    s_mov_b32 s101, 0
bc_21:
    ds_read_b32 v19, v18
    s_add_u32 s101, s101, 1
    s_cmp_gt_u32 s101, 0x3d0900
    s_cbranch_scc1 bcd_22
    s_waitcnt lgkmcnt(0)
    v_readfirstlane_b32 s71, v19
    s_nop 0
    s_cmp_eq_u32 s71, 0
    s_cbranch_scc1 bc_21
bcd_22:
    v_lshlrev_b32 v18, 1, v255
    v_add_u32 v18, 0x25800, v18
    ds_read_b128 v[232:235], v18 offset:0
    ds_read_b128 v[236:239], v18 offset:16
    ds_read_b128 v[240:243], v18 offset:32
    ds_read_b128 v[244:247], v18 offset:48
    s_waitcnt lgkmcnt(0)
    s_mov_b32 s101, 0
lw_23:
    ds_read_b32 v18, v8 offset:20
    s_add_u32 s101, s101, 1
    s_cmp_gt_u32 s101, 0x3d0900
    s_cbranch_scc1 lwd_24
    s_waitcnt lgkmcnt(0)
    v_readfirstlane_b32 s79, v18
    s_nop 0
    s_cmp_ge_u32 s79, 8
    s_cbranch_scc1 lwd_24
    s_branch lw_23
lwd_24:
    s_nop 0
    s_mul_i32 s72, s89, 0x2440
    v_add_u32 v11, s72, v4
    s_mov_b64 exec, s[90:91]
    v_pk_fma_f32 v[136:137], v[136:137], v[240:241], v[232:233]
    v_pk_fma_f32 v[138:139], v[138:139], v[242:243], v[234:235]
    v_pk_fma_f32 v[140:141], v[140:141], v[244:245], v[236:237]
    v_pk_fma_f32 v[142:143], v[142:143], v[246:247], v[238:239]
    v_cvt_pk_bf16_f32 v136, v136, v137
    v_cvt_pk_bf16_f32 v137, v138, v139
    v_cvt_pk_bf16_f32 v138, v140, v141
    v_cvt_pk_bf16_f32 v139, v142, v143
    ds_write_b128 v11, v[136:139] offset:0
    v_pk_fma_f32 v[144:145], v[144:145], v[240:241], v[232:233]
    v_pk_fma_f32 v[146:147], v[146:147], v[242:243], v[234:235]
    v_pk_fma_f32 v[148:149], v[148:149], v[244:245], v[236:237]
    v_pk_fma_f32 v[150:151], v[150:151], v[246:247], v[238:239]
    v_cvt_pk_bf16_f32 v144, v144, v145
    v_cvt_pk_bf16_f32 v145, v146, v147
    v_cvt_pk_bf16_f32 v146, v148, v149
    v_cvt_pk_bf16_f32 v147, v150, v151
    ds_write_b128 v11, v[144:147] offset:928
    v_pk_fma_f32 v[152:153], v[152:153], v[240:241], v[232:233]
    v_pk_fma_f32 v[154:155], v[154:155], v[242:243], v[234:235]
    v_pk_fma_f32 v[156:157], v[156:157], v[244:245], v[236:237]
    v_pk_fma_f32 v[158:159], v[158:159], v[246:247], v[238:239]
    v_cvt_pk_bf16_f32 v152, v152, v153
    v_cvt_pk_bf16_f32 v153, v154, v155
    v_cvt_pk_bf16_f32 v154, v156, v157
    v_cvt_pk_bf16_f32 v155, v158, v159
    ds_write_b128 v11, v[152:155] offset:1856
    v_pk_fma_f32 v[160:161], v[160:161], v[240:241], v[232:233]
    v_pk_fma_f32 v[162:163], v[162:163], v[242:243], v[234:235]
    v_pk_fma_f32 v[164:165], v[164:165], v[244:245], v[236:237]
    v_pk_fma_f32 v[166:167], v[166:167], v[246:247], v[238:239]
    v_cvt_pk_bf16_f32 v160, v160, v161
    v_cvt_pk_bf16_f32 v161, v162, v163
    v_cvt_pk_bf16_f32 v162, v164, v165
    v_cvt_pk_bf16_f32 v163, v166, v167
    ds_write_b128 v11, v[160:163] offset:2784
    v_pk_fma_f32 v[168:169], v[168:169], v[240:241], v[232:233]
    v_pk_fma_f32 v[170:171], v[170:171], v[242:243], v[234:235]
    v_pk_fma_f32 v[172:173], v[172:173], v[244:245], v[236:237]
    v_pk_fma_f32 v[174:175], v[174:175], v[246:247], v[238:239]
    v_cvt_pk_bf16_f32 v168, v168, v169
    v_cvt_pk_bf16_f32 v169, v170, v171
    v_cvt_pk_bf16_f32 v170, v172, v173
    v_cvt_pk_bf16_f32 v171, v174, v175
    ds_write_b128 v11, v[168:171] offset:3712
    v_pk_fma_f32 v[176:177], v[176:177], v[240:241], v[232:233]
    v_pk_fma_f32 v[178:179], v[178:179], v[242:243], v[234:235]
    v_pk_fma_f32 v[180:181], v[180:181], v[244:245], v[236:237]
    v_pk_fma_f32 v[182:183], v[182:183], v[246:247], v[238:239]
    v_cvt_pk_bf16_f32 v176, v176, v177
    v_cvt_pk_bf16_f32 v177, v178, v179
    v_cvt_pk_bf16_f32 v178, v180, v181
    v_cvt_pk_bf16_f32 v179, v182, v183
    ds_write_b128 v11, v[176:179] offset:4640
    v_pk_fma_f32 v[184:185], v[184:185], v[240:241], v[232:233]
    v_pk_fma_f32 v[186:187], v[186:187], v[242:243], v[234:235]
    v_pk_fma_f32 v[188:189], v[188:189], v[244:245], v[236:237]
    v_pk_fma_f32 v[190:191], v[190:191], v[246:247], v[238:239]
    v_cvt_pk_bf16_f32 v184, v184, v185
    v_cvt_pk_bf16_f32 v185, v186, v187
    v_cvt_pk_bf16_f32 v186, v188, v189
    v_cvt_pk_bf16_f32 v187, v190, v191
    ds_write_b128 v11, v[184:187] offset:5568
    v_pk_fma_f32 v[192:193], v[192:193], v[240:241], v[232:233]
    v_pk_fma_f32 v[194:195], v[194:195], v[242:243], v[234:235]
    v_pk_fma_f32 v[196:197], v[196:197], v[244:245], v[236:237]
    v_pk_fma_f32 v[198:199], v[198:199], v[246:247], v[238:239]
    v_cvt_pk_bf16_f32 v192, v192, v193
    v_cvt_pk_bf16_f32 v193, v194, v195
    v_cvt_pk_bf16_f32 v194, v196, v197
    v_cvt_pk_bf16_f32 v195, v198, v199
    ds_write_b128 v11, v[192:195] offset:6496
    v_pk_fma_f32 v[200:201], v[200:201], v[240:241], v[232:233]
    v_pk_fma_f32 v[202:203], v[202:203], v[242:243], v[234:235]
    v_pk_fma_f32 v[204:205], v[204:205], v[244:245], v[236:237]
    v_pk_fma_f32 v[206:207], v[206:207], v[246:247], v[238:239]
    v_cvt_pk_bf16_f32 v200, v200, v201
    v_cvt_pk_bf16_f32 v201, v202, v203
    v_cvt_pk_bf16_f32 v202, v204, v205
    v_cvt_pk_bf16_f32 v203, v206, v207
    ds_write_b128 v11, v[200:203] offset:7424
    v_pk_fma_f32 v[208:209], v[208:209], v[240:241], v[232:233]
    v_pk_fma_f32 v[210:211], v[210:211], v[242:243], v[234:235]
    v_pk_fma_f32 v[212:213], v[212:213], v[244:245], v[236:237]
    v_pk_fma_f32 v[214:215], v[214:215], v[246:247], v[238:239]
    v_cvt_pk_bf16_f32 v208, v208, v209
    v_cvt_pk_bf16_f32 v209, v210, v211
    v_cvt_pk_bf16_f32 v210, v212, v213
    v_cvt_pk_bf16_f32 v211, v214, v215
    ds_write_b128 v11, v[208:211] offset:8352
    s_mov_b64 exec, -1
L_gdone:
    s_nop 2
    s_waitcnt lgkmcnt(0)
    s_barrier
    v_lshrrev_b32 v8, 3, v1
    v_and_b32 v8, 6, v8
    v_xor_b32 v8, v8, v1
    v_and_b32 v8, 7, v8
    v_lshlrev_b32 v8, 4, v8
    v_lshrrev_b32 v19, 3, v1
    s_mov_b32 s79, 0x380
    v_mad_u32_u24 v8, v19, s79, v8
    s_lshr_b32 s75, s70, 1
    s_and_b32 s75, s75, 1
    s_cmp_ge_u32 s70, 4
    s_cbranch_scc1 L_A_q
    s_and_b32 s73, s70, 1
    s_cmp_eq_u32 s73, 1
    s_cbranch_scc1 L_A_v
    ds_read_b128 v[176:179], v5 offset:0
    ds_read_b128 v[180:183], v5 offset:14848
    ds_read_b128 v[184:187], v5 offset:29696
    ds_read_b128 v[188:191], v5 offset:44544
    ds_read_b128 v[192:195], v5 offset:59392
    ds_read_b128 v[196:199], v5 offset:64
    ds_read_b128 v[200:203], v5 offset:14912
    ds_read_b128 v[204:207], v5 offset:29760
    ds_read_b128 v[208:211], v5 offset:44608
    ds_read_b128 v[212:215], v5 offset:59456
    s_waitcnt lgkmcnt(9)
    v_mfma_f32_16x16x32_bf16 v[136:139], v[20:23], v[176:179], 0
    v_mfma_f32_16x16x32_bf16 v[140:143], v[24:27], v[176:179], 0
    s_waitcnt lgkmcnt(8)
    v_mfma_f32_16x16x32_bf16 v[144:147], v[20:23], v[180:183], 0
    v_mfma_f32_16x16x32_bf16 v[148:151], v[24:27], v[180:183], 0
    s_waitcnt lgkmcnt(7)
    v_mfma_f32_16x16x32_bf16 v[152:155], v[20:23], v[184:187], 0
    v_mfma_f32_16x16x32_bf16 v[156:159], v[24:27], v[184:187], 0
    s_waitcnt lgkmcnt(6)
    v_mfma_f32_16x16x32_bf16 v[160:163], v[20:23], v[188:191], 0
    v_mfma_f32_16x16x32_bf16 v[164:167], v[24:27], v[188:191], 0
    s_waitcnt lgkmcnt(5)
    v_mfma_f32_16x16x32_bf16 v[168:171], v[20:23], v[192:195], 0
    v_mfma_f32_16x16x32_bf16 v[172:175], v[24:27], v[192:195], 0
    ds_read_b128 v[176:179], v5 offset:128
    ds_read_b128 v[180:183], v5 offset:14976
    ds_read_b128 v[184:187], v5 offset:29824
    ds_read_b128 v[188:191], v5 offset:44672
    ds_read_b128 v[192:195], v5 offset:59520
    s_waitcnt lgkmcnt(9)
    v_mfma_f32_16x16x32_bf16 v[136:139], v[28:31], v[196:199], v[136:139]
    v_mfma_f32_16x16x32_bf16 v[140:143], v[32:35], v[196:199], v[140:143]
    s_waitcnt lgkmcnt(8)
    v_mfma_f32_16x16x32_bf16 v[144:147], v[28:31], v[200:203], v[144:147]
    v_mfma_f32_16x16x32_bf16 v[148:151], v[32:35], v[200:203], v[148:151]
    s_waitcnt lgkmcnt(7)
    v_mfma_f32_16x16x32_bf16 v[152:155], v[28:31], v[204:207], v[152:155]
    v_mfma_f32_16x16x32_bf16 v[156:159], v[32:35], v[204:207], v[156:159]
    s_waitcnt lgkmcnt(6)
    v_mfma_f32_16x16x32_bf16 v[160:163], v[28:31], v[208:211], v[160:163]
    v_mfma_f32_16x16x32_bf16 v[164:167], v[32:35], v[208:211], v[164:167]
    s_waitcnt lgkmcnt(5)
    v_mfma_f32_16x16x32_bf16 v[168:171], v[28:31], v[212:215], v[168:171]
    v_mfma_f32_16x16x32_bf16 v[172:175], v[32:35], v[212:215], v[172:175]
    ds_read_b128 v[196:199], v5 offset:192
    ds_read_b128 v[200:203], v5 offset:15040
    ds_read_b128 v[204:207], v5 offset:29888
    ds_read_b128 v[208:211], v5 offset:44736
    ds_read_b128 v[212:215], v5 offset:59584
    s_waitcnt lgkmcnt(9)
    v_mfma_f32_16x16x32_bf16 v[136:139], v[36:39], v[176:179], v[136:139]
    v_mfma_f32_16x16x32_bf16 v[140:143], v[40:43], v[176:179], v[140:143]
    s_waitcnt lgkmcnt(8)
    v_mfma_f32_16x16x32_bf16 v[144:147], v[36:39], v[180:183], v[144:147]
    v_mfma_f32_16x16x32_bf16 v[148:151], v[40:43], v[180:183], v[148:151]
    s_waitcnt lgkmcnt(7)
    v_mfma_f32_16x16x32_bf16 v[152:155], v[36:39], v[184:187], v[152:155]
    v_mfma_f32_16x16x32_bf16 v[156:159], v[40:43], v[184:187], v[156:159]
    s_waitcnt lgkmcnt(6)
    v_mfma_f32_16x16x32_bf16 v[160:163], v[36:39], v[188:191], v[160:163]
    v_mfma_f32_16x16x32_bf16 v[164:167], v[40:43], v[188:191], v[164:167]
    s_waitcnt lgkmcnt(5)
    v_mfma_f32_16x16x32_bf16 v[168:171], v[36:39], v[192:195], v[168:171]
    v_mfma_f32_16x16x32_bf16 v[172:175], v[40:43], v[192:195], v[172:175]
    ds_read_b128 v[176:179], v5 offset:256
    ds_read_b128 v[180:183], v5 offset:15104
    ds_read_b128 v[184:187], v5 offset:29952
    ds_read_b128 v[188:191], v5 offset:44800
    ds_read_b128 v[192:195], v5 offset:59648
    s_waitcnt lgkmcnt(9)
    v_mfma_f32_16x16x32_bf16 v[136:139], v[44:47], v[196:199], v[136:139]
    v_mfma_f32_16x16x32_bf16 v[140:143], v[48:51], v[196:199], v[140:143]
    s_waitcnt lgkmcnt(8)
    v_mfma_f32_16x16x32_bf16 v[144:147], v[44:47], v[200:203], v[144:147]
    v_mfma_f32_16x16x32_bf16 v[148:151], v[48:51], v[200:203], v[148:151]
    s_waitcnt lgkmcnt(7)
    v_mfma_f32_16x16x32_bf16 v[152:155], v[44:47], v[204:207], v[152:155]
    v_mfma_f32_16x16x32_bf16 v[156:159], v[48:51], v[204:207], v[156:159]
    s_waitcnt lgkmcnt(6)
    v_mfma_f32_16x16x32_bf16 v[160:163], v[44:47], v[208:211], v[160:163]
    v_mfma_f32_16x16x32_bf16 v[164:167], v[48:51], v[208:211], v[164:167]
    s_waitcnt lgkmcnt(5)
    v_mfma_f32_16x16x32_bf16 v[168:171], v[44:47], v[212:215], v[168:171]
    v_mfma_f32_16x16x32_bf16 v[172:175], v[48:51], v[212:215], v[172:175]
    s_barrier
    ds_read_b64_tr_b16 v[68:69], v252 offset:0
    ds_read_b64_tr_b16 v[70:71], v252 offset:512
    ds_read_b64_tr_b16 v[72:73], v253 offset:0
    ds_read_b64_tr_b16 v[74:75], v253 offset:512
    ds_read_b64_tr_b16 v[76:77], v252 offset:12288
    ds_read_b64_tr_b16 v[78:79], v252 offset:12800
    ds_read_b64_tr_b16 v[80:81], v253 offset:12288
    ds_read_b64_tr_b16 v[82:83], v253 offset:12800
    s_waitcnt lgkmcnt(11)
    ds_read_b64_tr_b16 v[84:85], v252 offset:24576
    ds_read_b64_tr_b16 v[86:87], v252 offset:25088
    ds_read_b64_tr_b16 v[88:89], v253 offset:24576
    ds_read_b64_tr_b16 v[90:91], v253 offset:25088
    s_waitcnt lgkmcnt(14)
    ds_read_b128 v[196:199], v5 offset:320
    s_waitcnt lgkmcnt(14)
    ds_read_b128 v[200:203], v5 offset:15168
    s_waitcnt lgkmcnt(14)
    ds_read_b128 v[204:207], v5 offset:30016
    s_waitcnt lgkmcnt(14)
    ds_read_b128 v[208:211], v5 offset:44864
    s_waitcnt lgkmcnt(14)
    ds_read_b128 v[212:215], v5 offset:59712
    v_mfma_f32_16x16x32_bf16 v[136:139], v[52:55], v[176:179], v[136:139]
    v_mfma_f32_16x16x32_bf16 v[140:143], v[56:59], v[176:179], v[140:143]
    v_mfma_f32_16x16x32_bf16 v[144:147], v[52:55], v[180:183], v[144:147]
    v_mfma_f32_16x16x32_bf16 v[148:151], v[56:59], v[180:183], v[148:151]
    v_mfma_f32_16x16x32_bf16 v[152:155], v[52:55], v[184:187], v[152:155]
    v_mfma_f32_16x16x32_bf16 v[156:159], v[56:59], v[184:187], v[156:159]
    v_mfma_f32_16x16x32_bf16 v[160:163], v[52:55], v[188:191], v[160:163]
    v_mfma_f32_16x16x32_bf16 v[164:167], v[56:59], v[188:191], v[164:167]
    v_mfma_f32_16x16x32_bf16 v[168:171], v[52:55], v[192:195], v[168:171]
    v_mfma_f32_16x16x32_bf16 v[172:175], v[56:59], v[192:195], v[172:175]
    s_waitcnt lgkmcnt(11)
    ds_read_b64_tr_b16 v[92:93], v252 offset:36864
    ds_read_b64_tr_b16 v[94:95], v252 offset:37376
    ds_read_b64_tr_b16 v[96:97], v253 offset:36864
    ds_read_b64_tr_b16 v[98:99], v253 offset:37376
    s_waitcnt lgkmcnt(11)
    ds_read_b64_tr_b16 v[100:101], v252 offset:49152
    ds_read_b64_tr_b16 v[102:103], v252 offset:49664
    ds_read_b64_tr_b16 v[104:105], v253 offset:49152
    ds_read_b64_tr_b16 v[106:107], v253 offset:49664
    s_waitcnt lgkmcnt(11)
    ds_read_b64_tr_b16 v[108:109], v252 offset:61440
    ds_read_b64_tr_b16 v[110:111], v252 offset:61952
    ds_read_b64_tr_b16 v[112:113], v253 offset:61440
    ds_read_b64_tr_b16 v[114:115], v253 offset:61952
    s_waitcnt lgkmcnt(14)
    ds_read_b128 v[176:179], v5 offset:384
    s_waitcnt lgkmcnt(14)
    ds_read_b128 v[180:183], v5 offset:15232
    s_waitcnt lgkmcnt(14)
    ds_read_b128 v[184:187], v5 offset:30080
    s_waitcnt lgkmcnt(14)
    ds_read_b128 v[188:191], v5 offset:44928
    s_waitcnt lgkmcnt(14)
    ds_read_b128 v[192:195], v5 offset:59776
    v_mfma_f32_16x16x32_bf16 v[136:139], v[60:63], v[196:199], v[136:139]
    v_mfma_f32_16x16x32_bf16 v[140:143], v[64:67], v[196:199], v[140:143]
    v_mfma_f32_16x16x32_bf16 v[144:147], v[60:63], v[200:203], v[144:147]
    v_mfma_f32_16x16x32_bf16 v[148:151], v[64:67], v[200:203], v[148:151]
    v_mfma_f32_16x16x32_bf16 v[152:155], v[60:63], v[204:207], v[152:155]
    v_mfma_f32_16x16x32_bf16 v[156:159], v[64:67], v[204:207], v[156:159]
    v_mfma_f32_16x16x32_bf16 v[160:163], v[60:63], v[208:211], v[160:163]
    v_mfma_f32_16x16x32_bf16 v[164:167], v[64:67], v[208:211], v[164:167]
    v_mfma_f32_16x16x32_bf16 v[168:171], v[60:63], v[212:215], v[168:171]
    v_mfma_f32_16x16x32_bf16 v[172:175], v[64:67], v[212:215], v[172:175]
    s_barrier
    s_waitcnt lgkmcnt(14)
    ds_read_b128 v[196:199], v5 offset:448
    s_waitcnt lgkmcnt(14)
    ds_read_b128 v[200:203], v5 offset:15296
    s_waitcnt lgkmcnt(14)
    ds_read_b128 v[204:207], v5 offset:30144
    s_waitcnt lgkmcnt(14)
    ds_read_b128 v[208:211], v5 offset:44992
    s_waitcnt lgkmcnt(14)
    ds_read_b128 v[212:215], v5 offset:59840
    s_waitcnt lgkmcnt(9)
    v_mfma_f32_16x16x32_bf16 v[136:139], v[68:71], v[176:179], v[136:139]
    v_mfma_f32_16x16x32_bf16 v[140:143], v[72:75], v[176:179], v[140:143]
    s_waitcnt lgkmcnt(8)
    v_mfma_f32_16x16x32_bf16 v[144:147], v[68:71], v[180:183], v[144:147]
    v_mfma_f32_16x16x32_bf16 v[148:151], v[72:75], v[180:183], v[148:151]
    s_waitcnt lgkmcnt(7)
    v_mfma_f32_16x16x32_bf16 v[152:155], v[68:71], v[184:187], v[152:155]
    v_mfma_f32_16x16x32_bf16 v[156:159], v[72:75], v[184:187], v[156:159]
    s_waitcnt lgkmcnt(6)
    v_mfma_f32_16x16x32_bf16 v[160:163], v[68:71], v[188:191], v[160:163]
    v_mfma_f32_16x16x32_bf16 v[164:167], v[72:75], v[188:191], v[164:167]
    s_waitcnt lgkmcnt(5)
    v_mfma_f32_16x16x32_bf16 v[168:171], v[68:71], v[192:195], v[168:171]
    v_mfma_f32_16x16x32_bf16 v[172:175], v[72:75], v[192:195], v[172:175]
    s_cmp_lg_u32 s70, 1
    s_cbranch_scc1 ntm2_25
    v_lshrrev_b32 v249, 5, v1
    v_mul_u32_u24 v249, 0x1500, v249
    v_and_b32 v248, 31, v1
    v_min_u32 v248, 20, v248
    v_lshl_add_u32 v249, v248, 7, v249
    s_mul_i32 s72, s2, 0x2a00
    s_add_u32 s72, s72, 0xa80
    buffer_load_dword v248, v249, s[52:55], s72 offen
ntm2_25:
    ds_read_b128 v[176:179], v5 offset:512
    ds_read_b128 v[180:183], v5 offset:15360
    ds_read_b128 v[184:187], v5 offset:30208
    ds_read_b128 v[188:191], v5 offset:45056
    ds_read_b128 v[192:195], v5 offset:59904
    s_waitcnt lgkmcnt(9)
    v_mfma_f32_16x16x32_bf16 v[136:139], v[76:79], v[196:199], v[136:139]
    v_mfma_f32_16x16x32_bf16 v[140:143], v[80:83], v[196:199], v[140:143]
    s_waitcnt lgkmcnt(8)
    v_mfma_f32_16x16x32_bf16 v[144:147], v[76:79], v[200:203], v[144:147]
    v_mfma_f32_16x16x32_bf16 v[148:151], v[80:83], v[200:203], v[148:151]
    s_waitcnt lgkmcnt(7)
    v_mfma_f32_16x16x32_bf16 v[152:155], v[76:79], v[204:207], v[152:155]
    v_mfma_f32_16x16x32_bf16 v[156:159], v[80:83], v[204:207], v[156:159]
    s_waitcnt lgkmcnt(6)
    v_mfma_f32_16x16x32_bf16 v[160:163], v[76:79], v[208:211], v[160:163]
    v_mfma_f32_16x16x32_bf16 v[164:167], v[80:83], v[208:211], v[164:167]
    s_waitcnt lgkmcnt(5)
    v_mfma_f32_16x16x32_bf16 v[168:171], v[76:79], v[212:215], v[168:171]
    v_mfma_f32_16x16x32_bf16 v[172:175], v[80:83], v[212:215], v[172:175]
    buffer_load_dwordx4 v[216:219], v8, s[36:39], s83 offen
    s_add_u32 s83, s83, 0x1c00
    buffer_load_dwordx4 v[220:223], v8, s[36:39], s83 offen
    s_add_u32 s83, s83, 0x1c00
    ds_read_b128 v[196:199], v5 offset:576
    ds_read_b128 v[200:203], v5 offset:15424
    ds_read_b128 v[204:207], v5 offset:30272
    ds_read_b128 v[208:211], v5 offset:45120
    ds_read_b128 v[212:215], v5 offset:59968
    s_waitcnt lgkmcnt(9)
    v_mfma_f32_16x16x32_bf16 v[136:139], v[84:87], v[176:179], v[136:139]
    v_mfma_f32_16x16x32_bf16 v[140:143], v[88:91], v[176:179], v[140:143]
    s_waitcnt lgkmcnt(8)
    v_mfma_f32_16x16x32_bf16 v[144:147], v[84:87], v[180:183], v[144:147]
    v_mfma_f32_16x16x32_bf16 v[148:151], v[88:91], v[180:183], v[148:151]
    s_waitcnt lgkmcnt(7)
    v_mfma_f32_16x16x32_bf16 v[152:155], v[84:87], v[184:187], v[152:155]
    v_mfma_f32_16x16x32_bf16 v[156:159], v[88:91], v[184:187], v[156:159]
    s_waitcnt lgkmcnt(6)
    v_mfma_f32_16x16x32_bf16 v[160:163], v[84:87], v[188:191], v[160:163]
    v_mfma_f32_16x16x32_bf16 v[164:167], v[88:91], v[188:191], v[164:167]
    s_waitcnt lgkmcnt(5)
    v_mfma_f32_16x16x32_bf16 v[168:171], v[84:87], v[192:195], v[168:171]
    v_mfma_f32_16x16x32_bf16 v[172:175], v[88:91], v[192:195], v[172:175]
    buffer_load_dwordx4 v[224:227], v8, s[36:39], s83 offen
    s_add_u32 s83, s83, 0x1c00
    buffer_load_dwordx4 v[228:231], v8, s[36:39], s83 offen
    s_add_u32 s83, s83, 0x1c00
    ds_read_b128 v[176:179], v5 offset:640
    ds_read_b128 v[180:183], v5 offset:15488
    ds_read_b128 v[184:187], v5 offset:30336
    ds_read_b128 v[188:191], v5 offset:45184
    ds_read_b128 v[192:195], v5 offset:60032
    s_waitcnt lgkmcnt(9)
    v_mfma_f32_16x16x32_bf16 v[136:139], v[92:95], v[196:199], v[136:139]
    v_mfma_f32_16x16x32_bf16 v[140:143], v[96:99], v[196:199], v[140:143]
    s_waitcnt lgkmcnt(8)
    v_mfma_f32_16x16x32_bf16 v[144:147], v[92:95], v[200:203], v[144:147]
    v_mfma_f32_16x16x32_bf16 v[148:151], v[96:99], v[200:203], v[148:151]
    s_waitcnt lgkmcnt(7)
    v_mfma_f32_16x16x32_bf16 v[152:155], v[92:95], v[204:207], v[152:155]
    v_mfma_f32_16x16x32_bf16 v[156:159], v[96:99], v[204:207], v[156:159]
    s_waitcnt lgkmcnt(6)
    v_mfma_f32_16x16x32_bf16 v[160:163], v[92:95], v[208:211], v[160:163]
    v_mfma_f32_16x16x32_bf16 v[164:167], v[96:99], v[208:211], v[164:167]
    s_waitcnt lgkmcnt(5)
    v_mfma_f32_16x16x32_bf16 v[168:171], v[92:95], v[212:215], v[168:171]
    v_mfma_f32_16x16x32_bf16 v[172:175], v[96:99], v[212:215], v[172:175]
    buffer_load_dwordx4 v[232:235], v8, s[36:39], s83 offen
    s_add_u32 s83, s83, 0x1c00
    buffer_load_dwordx4 v[236:239], v8, s[36:39], s83 offen
    s_add_u32 s83, s83, 0x1c00
    ds_read_b128 v[196:199], v5 offset:704
    ds_read_b128 v[200:203], v5 offset:15552
    ds_read_b128 v[204:207], v5 offset:30400
    ds_read_b128 v[208:211], v5 offset:45248
    ds_read_b128 v[212:215], v5 offset:60096
    s_waitcnt lgkmcnt(9)
    v_mfma_f32_16x16x32_bf16 v[136:139], v[100:103], v[176:179], v[136:139]
    v_mfma_f32_16x16x32_bf16 v[140:143], v[104:107], v[176:179], v[140:143]
    s_waitcnt lgkmcnt(8)
    v_mfma_f32_16x16x32_bf16 v[144:147], v[100:103], v[180:183], v[144:147]
    v_mfma_f32_16x16x32_bf16 v[148:151], v[104:107], v[180:183], v[148:151]
    s_waitcnt lgkmcnt(7)
    v_mfma_f32_16x16x32_bf16 v[152:155], v[100:103], v[184:187], v[152:155]
    v_mfma_f32_16x16x32_bf16 v[156:159], v[104:107], v[184:187], v[156:159]
    s_waitcnt lgkmcnt(6)
    v_mfma_f32_16x16x32_bf16 v[160:163], v[100:103], v[188:191], v[160:163]
    v_mfma_f32_16x16x32_bf16 v[164:167], v[104:107], v[188:191], v[164:167]
    s_waitcnt lgkmcnt(5)
    v_mfma_f32_16x16x32_bf16 v[168:171], v[100:103], v[192:195], v[168:171]
    v_mfma_f32_16x16x32_bf16 v[172:175], v[104:107], v[192:195], v[172:175]
    buffer_load_dwordx4 v[240:243], v8, s[36:39], s83 offen
    s_add_u32 s83, s83, 0x1c00
    buffer_load_dwordx4 v[244:247], v8, s[36:39], s83 offen
    s_add_u32 s83, s83, 0x1c00
    s_barrier
    ds_read_b64_tr_b16 v[116:117], v252 offset:0
    ds_read_b64_tr_b16 v[118:119], v252 offset:512
    ds_read_b64_tr_b16 v[120:121], v253 offset:0
    ds_read_b64_tr_b16 v[122:123], v253 offset:512
    ds_read_b64_tr_b16 v[124:125], v252 offset:12288
    ds_read_b64_tr_b16 v[126:127], v252 offset:12800
    ds_read_b64_tr_b16 v[128:129], v253 offset:12288
    ds_read_b64_tr_b16 v[130:131], v253 offset:12800
    ds_read_b128 v[176:179], v5 offset:768
    ds_read_b128 v[180:183], v5 offset:15616
    s_waitcnt lgkmcnt(14)
    ds_read_b128 v[184:187], v5 offset:30464
    s_waitcnt lgkmcnt(14)
    ds_read_b128 v[188:191], v5 offset:45312
    s_waitcnt lgkmcnt(14)
    ds_read_b128 v[192:195], v5 offset:60160
    v_mfma_f32_16x16x32_bf16 v[136:139], v[108:111], v[196:199], v[136:139]
    v_mfma_f32_16x16x32_bf16 v[140:143], v[112:115], v[196:199], v[140:143]
    v_mfma_f32_16x16x32_bf16 v[144:147], v[108:111], v[200:203], v[144:147]
    v_mfma_f32_16x16x32_bf16 v[148:151], v[112:115], v[200:203], v[148:151]
    v_mfma_f32_16x16x32_bf16 v[152:155], v[108:111], v[204:207], v[152:155]
    v_mfma_f32_16x16x32_bf16 v[156:159], v[112:115], v[204:207], v[156:159]
    s_waitcnt lgkmcnt(14)
    v_mfma_f32_16x16x32_bf16 v[160:163], v[108:111], v[208:211], v[160:163]
    v_mfma_f32_16x16x32_bf16 v[164:167], v[112:115], v[208:211], v[164:167]
    s_waitcnt lgkmcnt(13)
    v_mfma_f32_16x16x32_bf16 v[168:171], v[108:111], v[212:215], v[168:171]
    v_mfma_f32_16x16x32_bf16 v[172:175], v[112:115], v[212:215], v[172:175]
    s_cmp_lg_u32 s70, 2
    s_cbranch_scc1 ntch_26
    s_mul_i32 s72, s2, 0x1880
    v_min_u32 v249, 48, v1
    v_lshlrev_b32 v249, 7, v249
    buffer_load_dword v248, v249, s[44:47], s72 offen
ntch_26:
    ds_read_b128 v[196:199], v5 offset:832
    ds_read_b128 v[200:203], v5 offset:15680
    s_waitcnt lgkmcnt(14)
    ds_read_b128 v[204:207], v5 offset:30528
    s_waitcnt lgkmcnt(14)
    ds_read_b128 v[208:211], v5 offset:45376
    s_waitcnt lgkmcnt(14)
    ds_read_b128 v[212:215], v5 offset:60224
    s_waitcnt lgkmcnt(9)
    v_mfma_f32_16x16x32_bf16 v[136:139], v[116:119], v[176:179], v[136:139]
    v_mfma_f32_16x16x32_bf16 v[140:143], v[120:123], v[176:179], v[140:143]
    s_waitcnt lgkmcnt(8)
    v_mfma_f32_16x16x32_bf16 v[144:147], v[116:119], v[180:183], v[144:147]
    v_mfma_f32_16x16x32_bf16 v[148:151], v[120:123], v[180:183], v[148:151]
    s_waitcnt lgkmcnt(7)
    v_mfma_f32_16x16x32_bf16 v[152:155], v[116:119], v[184:187], v[152:155]
    v_mfma_f32_16x16x32_bf16 v[156:159], v[120:123], v[184:187], v[156:159]
    s_waitcnt lgkmcnt(6)
    v_mfma_f32_16x16x32_bf16 v[160:163], v[116:119], v[188:191], v[160:163]
    v_mfma_f32_16x16x32_bf16 v[164:167], v[120:123], v[188:191], v[164:167]
    s_waitcnt lgkmcnt(5)
    v_mfma_f32_16x16x32_bf16 v[168:171], v[116:119], v[192:195], v[168:171]
    v_mfma_f32_16x16x32_bf16 v[172:175], v[120:123], v[192:195], v[172:175]
    s_waitcnt lgkmcnt(4)
    v_mfma_f32_16x16x32_bf16 v[136:139], v[124:127], v[196:199], v[136:139]
    v_mfma_f32_16x16x32_bf16 v[140:143], v[128:131], v[196:199], v[140:143]
    s_waitcnt lgkmcnt(3)
    v_mfma_f32_16x16x32_bf16 v[144:147], v[124:127], v[200:203], v[144:147]
    v_mfma_f32_16x16x32_bf16 v[148:151], v[128:131], v[200:203], v[148:151]
    s_waitcnt lgkmcnt(2)
    v_mfma_f32_16x16x32_bf16 v[152:155], v[124:127], v[204:207], v[152:155]
    v_mfma_f32_16x16x32_bf16 v[156:159], v[128:131], v[204:207], v[156:159]
    s_waitcnt lgkmcnt(1)
    v_mfma_f32_16x16x32_bf16 v[160:163], v[124:127], v[208:211], v[160:163]
    v_mfma_f32_16x16x32_bf16 v[164:167], v[128:131], v[208:211], v[164:167]
    s_waitcnt lgkmcnt(0)
    v_mfma_f32_16x16x32_bf16 v[168:171], v[124:127], v[212:215], v[168:171]
    v_mfma_f32_16x16x32_bf16 v[172:175], v[128:131], v[212:215], v[172:175]
    v_cvt_pk_bf16_f32 v176, v136, v137
    v_cvt_pk_bf16_f32 v177, v138, v139
    v_cvt_pk_bf16_f32 v178, v140, v141
    v_cvt_pk_bf16_f32 v179, v142, v143
    v_cvt_pk_bf16_f32 v180, v144, v145
    v_cvt_pk_bf16_f32 v181, v146, v147
    v_cvt_pk_bf16_f32 v182, v148, v149
    v_cvt_pk_bf16_f32 v183, v150, v151
    v_cvt_pk_bf16_f32 v184, v152, v153
    v_cvt_pk_bf16_f32 v185, v154, v155
    v_cvt_pk_bf16_f32 v186, v156, v157
    v_cvt_pk_bf16_f32 v187, v158, v159
    v_cvt_pk_bf16_f32 v188, v160, v161
    v_cvt_pk_bf16_f32 v189, v162, v163
    v_cvt_pk_bf16_f32 v190, v164, v165
    v_cvt_pk_bf16_f32 v191, v166, v167
    v_cvt_pk_bf16_f32 v192, v168, v169
    v_cvt_pk_bf16_f32 v193, v170, v171
    v_cvt_pk_bf16_f32 v194, v172, v173
    v_cvt_pk_bf16_f32 v195, v174, v175
    s_mul_i32 s73, s75, 0x1400
    s_add_u32 s73, s73, 0x1a200
    v_add_u32 v10, s73, v4
    ds_write_b128 v10, v[176:179] offset:0
    ds_write_b128 v10, v[180:183] offset:1024
    ds_write_b128 v10, v[184:187] offset:2048
    ds_write_b128 v10, v[188:191] offset:3072
    ds_write_b128 v10, v[192:195] offset:4096
    s_branch L_A_done
L_A_v:
    ds_read_b128 v[176:179], v5 offset:0
    ds_read_b128 v[180:183], v5 offset:14848
    ds_read_b128 v[184:187], v5 offset:29696
    ds_read_b128 v[188:191], v5 offset:44544
    ds_read_b128 v[192:195], v5 offset:59392
    ds_read_b128 v[196:199], v5 offset:64
    ds_read_b128 v[200:203], v5 offset:14912
    ds_read_b128 v[204:207], v5 offset:29760
    ds_read_b128 v[208:211], v5 offset:44608
    ds_read_b128 v[212:215], v5 offset:59456
    s_waitcnt lgkmcnt(9)
    v_mfma_f32_16x16x32_bf16 v[136:139], v[176:179], v[20:23], 0
    v_mfma_f32_16x16x32_bf16 v[140:143], v[176:179], v[24:27], 0
    s_waitcnt lgkmcnt(8)
    v_mfma_f32_16x16x32_bf16 v[144:147], v[180:183], v[20:23], 0
    v_mfma_f32_16x16x32_bf16 v[148:151], v[180:183], v[24:27], 0
    s_waitcnt lgkmcnt(7)
    v_mfma_f32_16x16x32_bf16 v[152:155], v[184:187], v[20:23], 0
    v_mfma_f32_16x16x32_bf16 v[156:159], v[184:187], v[24:27], 0
    s_waitcnt lgkmcnt(6)
    v_mfma_f32_16x16x32_bf16 v[160:163], v[188:191], v[20:23], 0
    v_mfma_f32_16x16x32_bf16 v[164:167], v[188:191], v[24:27], 0
    s_waitcnt lgkmcnt(5)
    v_mfma_f32_16x16x32_bf16 v[168:171], v[192:195], v[20:23], 0
    v_mfma_f32_16x16x32_bf16 v[172:175], v[192:195], v[24:27], 0
    ds_read_b128 v[176:179], v5 offset:128
    ds_read_b128 v[180:183], v5 offset:14976
    ds_read_b128 v[184:187], v5 offset:29824
    ds_read_b128 v[188:191], v5 offset:44672
    ds_read_b128 v[192:195], v5 offset:59520
    s_waitcnt lgkmcnt(9)
    v_mfma_f32_16x16x32_bf16 v[136:139], v[196:199], v[28:31], v[136:139]
    v_mfma_f32_16x16x32_bf16 v[140:143], v[196:199], v[32:35], v[140:143]
    s_waitcnt lgkmcnt(8)
    v_mfma_f32_16x16x32_bf16 v[144:147], v[200:203], v[28:31], v[144:147]
    v_mfma_f32_16x16x32_bf16 v[148:151], v[200:203], v[32:35], v[148:151]
    s_waitcnt lgkmcnt(7)
    v_mfma_f32_16x16x32_bf16 v[152:155], v[204:207], v[28:31], v[152:155]
    v_mfma_f32_16x16x32_bf16 v[156:159], v[204:207], v[32:35], v[156:159]
    s_waitcnt lgkmcnt(6)
    v_mfma_f32_16x16x32_bf16 v[160:163], v[208:211], v[28:31], v[160:163]
    v_mfma_f32_16x16x32_bf16 v[164:167], v[208:211], v[32:35], v[164:167]
    s_waitcnt lgkmcnt(5)
    v_mfma_f32_16x16x32_bf16 v[168:171], v[212:215], v[28:31], v[168:171]
    v_mfma_f32_16x16x32_bf16 v[172:175], v[212:215], v[32:35], v[172:175]
    ds_read_b128 v[196:199], v5 offset:192
    ds_read_b128 v[200:203], v5 offset:15040
    ds_read_b128 v[204:207], v5 offset:29888
    ds_read_b128 v[208:211], v5 offset:44736
    ds_read_b128 v[212:215], v5 offset:59584
    s_waitcnt lgkmcnt(9)
    v_mfma_f32_16x16x32_bf16 v[136:139], v[176:179], v[36:39], v[136:139]
    v_mfma_f32_16x16x32_bf16 v[140:143], v[176:179], v[40:43], v[140:143]
    s_waitcnt lgkmcnt(8)
    v_mfma_f32_16x16x32_bf16 v[144:147], v[180:183], v[36:39], v[144:147]
    v_mfma_f32_16x16x32_bf16 v[148:151], v[180:183], v[40:43], v[148:151]
    s_waitcnt lgkmcnt(7)
    v_mfma_f32_16x16x32_bf16 v[152:155], v[184:187], v[36:39], v[152:155]
    v_mfma_f32_16x16x32_bf16 v[156:159], v[184:187], v[40:43], v[156:159]
    s_waitcnt lgkmcnt(6)
    v_mfma_f32_16x16x32_bf16 v[160:163], v[188:191], v[36:39], v[160:163]
    v_mfma_f32_16x16x32_bf16 v[164:167], v[188:191], v[40:43], v[164:167]
    s_waitcnt lgkmcnt(5)
    v_mfma_f32_16x16x32_bf16 v[168:171], v[192:195], v[36:39], v[168:171]
    v_mfma_f32_16x16x32_bf16 v[172:175], v[192:195], v[40:43], v[172:175]
    ds_read_b128 v[176:179], v5 offset:256
    ds_read_b128 v[180:183], v5 offset:15104
    ds_read_b128 v[184:187], v5 offset:29952
    ds_read_b128 v[188:191], v5 offset:44800
    ds_read_b128 v[192:195], v5 offset:59648
    s_waitcnt lgkmcnt(9)
    v_mfma_f32_16x16x32_bf16 v[136:139], v[196:199], v[44:47], v[136:139]
    v_mfma_f32_16x16x32_bf16 v[140:143], v[196:199], v[48:51], v[140:143]
    s_waitcnt lgkmcnt(8)
    v_mfma_f32_16x16x32_bf16 v[144:147], v[200:203], v[44:47], v[144:147]
    v_mfma_f32_16x16x32_bf16 v[148:151], v[200:203], v[48:51], v[148:151]
    s_waitcnt lgkmcnt(7)
    v_mfma_f32_16x16x32_bf16 v[152:155], v[204:207], v[44:47], v[152:155]
    v_mfma_f32_16x16x32_bf16 v[156:159], v[204:207], v[48:51], v[156:159]
    s_waitcnt lgkmcnt(6)
    v_mfma_f32_16x16x32_bf16 v[160:163], v[208:211], v[44:47], v[160:163]
    v_mfma_f32_16x16x32_bf16 v[164:167], v[208:211], v[48:51], v[164:167]
    s_waitcnt lgkmcnt(5)
    v_mfma_f32_16x16x32_bf16 v[168:171], v[212:215], v[44:47], v[168:171]
    v_mfma_f32_16x16x32_bf16 v[172:175], v[212:215], v[48:51], v[172:175]
    s_barrier
    ds_read_b64_tr_b16 v[68:69], v252 offset:0
    ds_read_b64_tr_b16 v[70:71], v252 offset:512
    ds_read_b64_tr_b16 v[72:73], v253 offset:0
    ds_read_b64_tr_b16 v[74:75], v253 offset:512
    ds_read_b64_tr_b16 v[76:77], v252 offset:12288
    ds_read_b64_tr_b16 v[78:79], v252 offset:12800
    ds_read_b64_tr_b16 v[80:81], v253 offset:12288
    ds_read_b64_tr_b16 v[82:83], v253 offset:12800
    s_waitcnt lgkmcnt(11)
    ds_read_b64_tr_b16 v[84:85], v252 offset:24576
    ds_read_b64_tr_b16 v[86:87], v252 offset:25088
    ds_read_b64_tr_b16 v[88:89], v253 offset:24576
    ds_read_b64_tr_b16 v[90:91], v253 offset:25088
    s_waitcnt lgkmcnt(14)
    ds_read_b128 v[196:199], v5 offset:320
    s_waitcnt lgkmcnt(14)
    ds_read_b128 v[200:203], v5 offset:15168
    s_waitcnt lgkmcnt(14)
    ds_read_b128 v[204:207], v5 offset:30016
    s_waitcnt lgkmcnt(14)
    ds_read_b128 v[208:211], v5 offset:44864
    s_waitcnt lgkmcnt(14)
    ds_read_b128 v[212:215], v5 offset:59712
    v_mfma_f32_16x16x32_bf16 v[136:139], v[176:179], v[52:55], v[136:139]
    v_mfma_f32_16x16x32_bf16 v[140:143], v[176:179], v[56:59], v[140:143]
    v_mfma_f32_16x16x32_bf16 v[144:147], v[180:183], v[52:55], v[144:147]
    v_mfma_f32_16x16x32_bf16 v[148:151], v[180:183], v[56:59], v[148:151]
    v_mfma_f32_16x16x32_bf16 v[152:155], v[184:187], v[52:55], v[152:155]
    v_mfma_f32_16x16x32_bf16 v[156:159], v[184:187], v[56:59], v[156:159]
    v_mfma_f32_16x16x32_bf16 v[160:163], v[188:191], v[52:55], v[160:163]
    v_mfma_f32_16x16x32_bf16 v[164:167], v[188:191], v[56:59], v[164:167]
    v_mfma_f32_16x16x32_bf16 v[168:171], v[192:195], v[52:55], v[168:171]
    v_mfma_f32_16x16x32_bf16 v[172:175], v[192:195], v[56:59], v[172:175]
    s_waitcnt lgkmcnt(11)
    ds_read_b64_tr_b16 v[92:93], v252 offset:36864
    ds_read_b64_tr_b16 v[94:95], v252 offset:37376
    ds_read_b64_tr_b16 v[96:97], v253 offset:36864
    ds_read_b64_tr_b16 v[98:99], v253 offset:37376
    s_waitcnt lgkmcnt(11)
    ds_read_b64_tr_b16 v[100:101], v252 offset:49152
    ds_read_b64_tr_b16 v[102:103], v252 offset:49664
    ds_read_b64_tr_b16 v[104:105], v253 offset:49152
    ds_read_b64_tr_b16 v[106:107], v253 offset:49664
    s_waitcnt lgkmcnt(11)
    ds_read_b64_tr_b16 v[108:109], v252 offset:61440
    ds_read_b64_tr_b16 v[110:111], v252 offset:61952
    ds_read_b64_tr_b16 v[112:113], v253 offset:61440
    ds_read_b64_tr_b16 v[114:115], v253 offset:61952
    s_waitcnt lgkmcnt(14)
    ds_read_b128 v[176:179], v5 offset:384
    s_waitcnt lgkmcnt(14)
    ds_read_b128 v[180:183], v5 offset:15232
    s_waitcnt lgkmcnt(14)
    ds_read_b128 v[184:187], v5 offset:30080
    s_waitcnt lgkmcnt(14)
    ds_read_b128 v[188:191], v5 offset:44928
    s_waitcnt lgkmcnt(14)
    ds_read_b128 v[192:195], v5 offset:59776
    v_mfma_f32_16x16x32_bf16 v[136:139], v[196:199], v[60:63], v[136:139]
    v_mfma_f32_16x16x32_bf16 v[140:143], v[196:199], v[64:67], v[140:143]
    v_mfma_f32_16x16x32_bf16 v[144:147], v[200:203], v[60:63], v[144:147]
    v_mfma_f32_16x16x32_bf16 v[148:151], v[200:203], v[64:67], v[148:151]
    v_mfma_f32_16x16x32_bf16 v[152:155], v[204:207], v[60:63], v[152:155]
    v_mfma_f32_16x16x32_bf16 v[156:159], v[204:207], v[64:67], v[156:159]
    v_mfma_f32_16x16x32_bf16 v[160:163], v[208:211], v[60:63], v[160:163]
    v_mfma_f32_16x16x32_bf16 v[164:167], v[208:211], v[64:67], v[164:167]
    v_mfma_f32_16x16x32_bf16 v[168:171], v[212:215], v[60:63], v[168:171]
    v_mfma_f32_16x16x32_bf16 v[172:175], v[212:215], v[64:67], v[172:175]
    s_barrier
    s_waitcnt lgkmcnt(14)
    ds_read_b128 v[196:199], v5 offset:448
    s_waitcnt lgkmcnt(14)
    ds_read_b128 v[200:203], v5 offset:15296
    s_waitcnt lgkmcnt(14)
    ds_read_b128 v[204:207], v5 offset:30144
    s_waitcnt lgkmcnt(14)
    ds_read_b128 v[208:211], v5 offset:44992
    s_waitcnt lgkmcnt(14)
    ds_read_b128 v[212:215], v5 offset:59840
    s_waitcnt lgkmcnt(9)
    v_mfma_f32_16x16x32_bf16 v[136:139], v[176:179], v[68:71], v[136:139]
    v_mfma_f32_16x16x32_bf16 v[140:143], v[176:179], v[72:75], v[140:143]
    s_waitcnt lgkmcnt(8)
    v_mfma_f32_16x16x32_bf16 v[144:147], v[180:183], v[68:71], v[144:147]
    v_mfma_f32_16x16x32_bf16 v[148:151], v[180:183], v[72:75], v[148:151]
    s_waitcnt lgkmcnt(7)
    v_mfma_f32_16x16x32_bf16 v[152:155], v[184:187], v[68:71], v[152:155]
    v_mfma_f32_16x16x32_bf16 v[156:159], v[184:187], v[72:75], v[156:159]
    s_waitcnt lgkmcnt(6)
    v_mfma_f32_16x16x32_bf16 v[160:163], v[188:191], v[68:71], v[160:163]
    v_mfma_f32_16x16x32_bf16 v[164:167], v[188:191], v[72:75], v[164:167]
    s_waitcnt lgkmcnt(5)
    v_mfma_f32_16x16x32_bf16 v[168:171], v[192:195], v[68:71], v[168:171]
    v_mfma_f32_16x16x32_bf16 v[172:175], v[192:195], v[72:75], v[172:175]
    s_cmp_lg_u32 s70, 1
    s_cbranch_scc1 ntm2_27
    v_lshrrev_b32 v249, 5, v1
    v_mul_u32_u24 v249, 0x1500, v249
    v_and_b32 v248, 31, v1
    v_min_u32 v248, 20, v248
    v_lshl_add_u32 v249, v248, 7, v249
    s_mul_i32 s72, s2, 0x2a00
    s_add_u32 s72, s72, 0xa80
    buffer_load_dword v248, v249, s[52:55], s72 offen
ntm2_27:
    ds_read_b128 v[176:179], v5 offset:512
    ds_read_b128 v[180:183], v5 offset:15360
    ds_read_b128 v[184:187], v5 offset:30208
    ds_read_b128 v[188:191], v5 offset:45056
    ds_read_b128 v[192:195], v5 offset:59904
    s_waitcnt lgkmcnt(9)
    v_mfma_f32_16x16x32_bf16 v[136:139], v[196:199], v[76:79], v[136:139]
    v_mfma_f32_16x16x32_bf16 v[140:143], v[196:199], v[80:83], v[140:143]
    s_waitcnt lgkmcnt(8)
    v_mfma_f32_16x16x32_bf16 v[144:147], v[200:203], v[76:79], v[144:147]
    v_mfma_f32_16x16x32_bf16 v[148:151], v[200:203], v[80:83], v[148:151]
    s_waitcnt lgkmcnt(7)
    v_mfma_f32_16x16x32_bf16 v[152:155], v[204:207], v[76:79], v[152:155]
    v_mfma_f32_16x16x32_bf16 v[156:159], v[204:207], v[80:83], v[156:159]
    s_waitcnt lgkmcnt(6)
    v_mfma_f32_16x16x32_bf16 v[160:163], v[208:211], v[76:79], v[160:163]
    v_mfma_f32_16x16x32_bf16 v[164:167], v[208:211], v[80:83], v[164:167]
    s_waitcnt lgkmcnt(5)
    v_mfma_f32_16x16x32_bf16 v[168:171], v[212:215], v[76:79], v[168:171]
    v_mfma_f32_16x16x32_bf16 v[172:175], v[212:215], v[80:83], v[172:175]
    buffer_load_dwordx4 v[216:219], v8, s[36:39], s83 offen
    s_add_u32 s83, s83, 0x1c00
    buffer_load_dwordx4 v[220:223], v8, s[36:39], s83 offen
    s_add_u32 s83, s83, 0x1c00
    ds_read_b128 v[196:199], v5 offset:576
    ds_read_b128 v[200:203], v5 offset:15424
    ds_read_b128 v[204:207], v5 offset:30272
    ds_read_b128 v[208:211], v5 offset:45120
    ds_read_b128 v[212:215], v5 offset:59968
    s_waitcnt lgkmcnt(9)
    v_mfma_f32_16x16x32_bf16 v[136:139], v[176:179], v[84:87], v[136:139]
    v_mfma_f32_16x16x32_bf16 v[140:143], v[176:179], v[88:91], v[140:143]
    s_waitcnt lgkmcnt(8)
    v_mfma_f32_16x16x32_bf16 v[144:147], v[180:183], v[84:87], v[144:147]
    v_mfma_f32_16x16x32_bf16 v[148:151], v[180:183], v[88:91], v[148:151]
    s_waitcnt lgkmcnt(7)
    v_mfma_f32_16x16x32_bf16 v[152:155], v[184:187], v[84:87], v[152:155]
    v_mfma_f32_16x16x32_bf16 v[156:159], v[184:187], v[88:91], v[156:159]
    s_waitcnt lgkmcnt(6)
    v_mfma_f32_16x16x32_bf16 v[160:163], v[188:191], v[84:87], v[160:163]
    v_mfma_f32_16x16x32_bf16 v[164:167], v[188:191], v[88:91], v[164:167]
    s_waitcnt lgkmcnt(5)
    v_mfma_f32_16x16x32_bf16 v[168:171], v[192:195], v[84:87], v[168:171]
    v_mfma_f32_16x16x32_bf16 v[172:175], v[192:195], v[88:91], v[172:175]
    buffer_load_dwordx4 v[224:227], v8, s[36:39], s83 offen
    s_add_u32 s83, s83, 0x1c00
    buffer_load_dwordx4 v[228:231], v8, s[36:39], s83 offen
    s_add_u32 s83, s83, 0x1c00
    ds_read_b128 v[176:179], v5 offset:640
    ds_read_b128 v[180:183], v5 offset:15488
    ds_read_b128 v[184:187], v5 offset:30336
    ds_read_b128 v[188:191], v5 offset:45184
    ds_read_b128 v[192:195], v5 offset:60032
    s_waitcnt lgkmcnt(9)
    v_mfma_f32_16x16x32_bf16 v[136:139], v[196:199], v[92:95], v[136:139]
    v_mfma_f32_16x16x32_bf16 v[140:143], v[196:199], v[96:99], v[140:143]
    s_waitcnt lgkmcnt(8)
    v_mfma_f32_16x16x32_bf16 v[144:147], v[200:203], v[92:95], v[144:147]
    v_mfma_f32_16x16x32_bf16 v[148:151], v[200:203], v[96:99], v[148:151]
    s_waitcnt lgkmcnt(7)
    v_mfma_f32_16x16x32_bf16 v[152:155], v[204:207], v[92:95], v[152:155]
    v_mfma_f32_16x16x32_bf16 v[156:159], v[204:207], v[96:99], v[156:159]
    s_waitcnt lgkmcnt(6)
    v_mfma_f32_16x16x32_bf16 v[160:163], v[208:211], v[92:95], v[160:163]
    v_mfma_f32_16x16x32_bf16 v[164:167], v[208:211], v[96:99], v[164:167]
    s_waitcnt lgkmcnt(5)
    v_mfma_f32_16x16x32_bf16 v[168:171], v[212:215], v[92:95], v[168:171]
    v_mfma_f32_16x16x32_bf16 v[172:175], v[212:215], v[96:99], v[172:175]
    buffer_load_dwordx4 v[232:235], v8, s[36:39], s83 offen
    s_add_u32 s83, s83, 0x1c00
    buffer_load_dwordx4 v[236:239], v8, s[36:39], s83 offen
    s_add_u32 s83, s83, 0x1c00
    ds_read_b128 v[196:199], v5 offset:704
    ds_read_b128 v[200:203], v5 offset:15552
    ds_read_b128 v[204:207], v5 offset:30400
    ds_read_b128 v[208:211], v5 offset:45248
    ds_read_b128 v[212:215], v5 offset:60096
    s_waitcnt lgkmcnt(9)
    v_mfma_f32_16x16x32_bf16 v[136:139], v[176:179], v[100:103], v[136:139]
    v_mfma_f32_16x16x32_bf16 v[140:143], v[176:179], v[104:107], v[140:143]
    s_waitcnt lgkmcnt(8)
    v_mfma_f32_16x16x32_bf16 v[144:147], v[180:183], v[100:103], v[144:147]
    v_mfma_f32_16x16x32_bf16 v[148:151], v[180:183], v[104:107], v[148:151]
    s_waitcnt lgkmcnt(7)
    v_mfma_f32_16x16x32_bf16 v[152:155], v[184:187], v[100:103], v[152:155]
    v_mfma_f32_16x16x32_bf16 v[156:159], v[184:187], v[104:107], v[156:159]
    s_waitcnt lgkmcnt(6)
    v_mfma_f32_16x16x32_bf16 v[160:163], v[188:191], v[100:103], v[160:163]
    v_mfma_f32_16x16x32_bf16 v[164:167], v[188:191], v[104:107], v[164:167]
    s_waitcnt lgkmcnt(5)
    v_mfma_f32_16x16x32_bf16 v[168:171], v[192:195], v[100:103], v[168:171]
    v_mfma_f32_16x16x32_bf16 v[172:175], v[192:195], v[104:107], v[172:175]
    buffer_load_dwordx4 v[240:243], v8, s[36:39], s83 offen
    s_add_u32 s83, s83, 0x1c00
    buffer_load_dwordx4 v[244:247], v8, s[36:39], s83 offen
    s_add_u32 s83, s83, 0x1c00
    s_barrier
    ds_read_b64_tr_b16 v[116:117], v252 offset:0
    ds_read_b64_tr_b16 v[118:119], v252 offset:512
    ds_read_b64_tr_b16 v[120:121], v253 offset:0
    ds_read_b64_tr_b16 v[122:123], v253 offset:512
    ds_read_b64_tr_b16 v[124:125], v252 offset:12288
    ds_read_b64_tr_b16 v[126:127], v252 offset:12800
    ds_read_b64_tr_b16 v[128:129], v253 offset:12288
    ds_read_b64_tr_b16 v[130:131], v253 offset:12800
    ds_read_b128 v[176:179], v5 offset:768
    ds_read_b128 v[180:183], v5 offset:15616
    s_waitcnt lgkmcnt(14)
    ds_read_b128 v[184:187], v5 offset:30464
    s_waitcnt lgkmcnt(14)
    ds_read_b128 v[188:191], v5 offset:45312
    s_waitcnt lgkmcnt(14)
    ds_read_b128 v[192:195], v5 offset:60160
    v_mfma_f32_16x16x32_bf16 v[136:139], v[196:199], v[108:111], v[136:139]
    v_mfma_f32_16x16x32_bf16 v[140:143], v[196:199], v[112:115], v[140:143]
    v_mfma_f32_16x16x32_bf16 v[144:147], v[200:203], v[108:111], v[144:147]
    v_mfma_f32_16x16x32_bf16 v[148:151], v[200:203], v[112:115], v[148:151]
    v_mfma_f32_16x16x32_bf16 v[152:155], v[204:207], v[108:111], v[152:155]
    v_mfma_f32_16x16x32_bf16 v[156:159], v[204:207], v[112:115], v[156:159]
    s_waitcnt lgkmcnt(14)
    v_mfma_f32_16x16x32_bf16 v[160:163], v[208:211], v[108:111], v[160:163]
    v_mfma_f32_16x16x32_bf16 v[164:167], v[208:211], v[112:115], v[164:167]
    s_waitcnt lgkmcnt(13)
    v_mfma_f32_16x16x32_bf16 v[168:171], v[212:215], v[108:111], v[168:171]
    v_mfma_f32_16x16x32_bf16 v[172:175], v[212:215], v[112:115], v[172:175]
    s_cmp_lg_u32 s70, 2
    s_cbranch_scc1 ntch_28
    s_mul_i32 s72, s2, 0x1880
    v_min_u32 v249, 48, v1
    v_lshlrev_b32 v249, 7, v249
    buffer_load_dword v248, v249, s[44:47], s72 offen
ntch_28:
    ds_read_b128 v[196:199], v5 offset:832
    ds_read_b128 v[200:203], v5 offset:15680
    s_waitcnt lgkmcnt(14)
    ds_read_b128 v[204:207], v5 offset:30528
    s_waitcnt lgkmcnt(14)
    ds_read_b128 v[208:211], v5 offset:45376
    s_waitcnt lgkmcnt(14)
    ds_read_b128 v[212:215], v5 offset:60224
    s_waitcnt lgkmcnt(9)
    v_mfma_f32_16x16x32_bf16 v[136:139], v[176:179], v[116:119], v[136:139]
    v_mfma_f32_16x16x32_bf16 v[140:143], v[176:179], v[120:123], v[140:143]
    s_waitcnt lgkmcnt(8)
    v_mfma_f32_16x16x32_bf16 v[144:147], v[180:183], v[116:119], v[144:147]
    v_mfma_f32_16x16x32_bf16 v[148:151], v[180:183], v[120:123], v[148:151]
    s_waitcnt lgkmcnt(7)
    v_mfma_f32_16x16x32_bf16 v[152:155], v[184:187], v[116:119], v[152:155]
    v_mfma_f32_16x16x32_bf16 v[156:159], v[184:187], v[120:123], v[156:159]
    s_waitcnt lgkmcnt(6)
    v_mfma_f32_16x16x32_bf16 v[160:163], v[188:191], v[116:119], v[160:163]
    v_mfma_f32_16x16x32_bf16 v[164:167], v[188:191], v[120:123], v[164:167]
    s_waitcnt lgkmcnt(5)
    v_mfma_f32_16x16x32_bf16 v[168:171], v[192:195], v[116:119], v[168:171]
    v_mfma_f32_16x16x32_bf16 v[172:175], v[192:195], v[120:123], v[172:175]
    s_waitcnt lgkmcnt(4)
    v_mfma_f32_16x16x32_bf16 v[136:139], v[196:199], v[124:127], v[136:139]
    v_mfma_f32_16x16x32_bf16 v[140:143], v[196:199], v[128:131], v[140:143]
    s_waitcnt lgkmcnt(3)
    v_mfma_f32_16x16x32_bf16 v[144:147], v[200:203], v[124:127], v[144:147]
    v_mfma_f32_16x16x32_bf16 v[148:151], v[200:203], v[128:131], v[148:151]
    s_waitcnt lgkmcnt(2)
    v_mfma_f32_16x16x32_bf16 v[152:155], v[204:207], v[124:127], v[152:155]
    v_mfma_f32_16x16x32_bf16 v[156:159], v[204:207], v[128:131], v[156:159]
    s_waitcnt lgkmcnt(1)
    v_mfma_f32_16x16x32_bf16 v[160:163], v[208:211], v[124:127], v[160:163]
    v_mfma_f32_16x16x32_bf16 v[164:167], v[208:211], v[128:131], v[164:167]
    s_waitcnt lgkmcnt(0)
    v_mfma_f32_16x16x32_bf16 v[168:171], v[212:215], v[124:127], v[168:171]
    v_mfma_f32_16x16x32_bf16 v[172:175], v[212:215], v[128:131], v[172:175]
    v_cvt_pk_bf16_f32 v176, v136, v137
    v_cvt_pk_bf16_f32 v177, v138, v139
    v_cvt_pk_bf16_f32 v178, v140, v141
    v_cvt_pk_bf16_f32 v179, v142, v143
    v_cvt_pk_bf16_f32 v180, v144, v145
    v_cvt_pk_bf16_f32 v181, v146, v147
    v_cvt_pk_bf16_f32 v182, v148, v149
    v_cvt_pk_bf16_f32 v183, v150, v151
    v_cvt_pk_bf16_f32 v184, v152, v153
    v_cvt_pk_bf16_f32 v185, v154, v155
    v_cvt_pk_bf16_f32 v186, v156, v157
    v_cvt_pk_bf16_f32 v187, v158, v159
    v_cvt_pk_bf16_f32 v188, v160, v161
    v_cvt_pk_bf16_f32 v189, v162, v163
    v_cvt_pk_bf16_f32 v190, v164, v165
    v_cvt_pk_bf16_f32 v191, v166, v167
    v_cvt_pk_bf16_f32 v192, v168, v169
    v_cvt_pk_bf16_f32 v193, v170, v171
    v_cvt_pk_bf16_f32 v194, v172, v173
    v_cvt_pk_bf16_f32 v195, v174, v175
    s_mul_i32 s73, s75, 0x1400
    s_add_u32 s73, s73, 0x1ca00
    v_add_u32 v10, s73, v4
    ds_write_b128 v10, v[176:179] offset:0
    ds_write_b128 v10, v[180:183] offset:1024
    ds_write_b128 v10, v[184:187] offset:2048
    ds_write_b128 v10, v[188:191] offset:3072
    ds_write_b128 v10, v[192:195] offset:4096
    s_branch L_A_done
L_A_q:
    s_and_b32 s73, s70, 1
    s_mul_i32 s74, s73, 0x7400
    v_add_u32 v5, s74, v5
    ds_read_b128 v[176:179], v5 offset:14848
    ds_read_b128 v[180:183], v5 offset:29696
    ds_read_b128 v[196:199], v5 offset:14912
    ds_read_b128 v[200:203], v5 offset:29760
    s_waitcnt lgkmcnt(3)
    v_mfma_f32_16x16x32_bf16 v[136:139], v[20:23], v[176:179], 0
    v_mfma_f32_16x16x32_bf16 v[140:143], v[24:27], v[176:179], 0
    s_waitcnt lgkmcnt(2)
    v_mfma_f32_16x16x32_bf16 v[144:147], v[20:23], v[180:183], 0
    v_mfma_f32_16x16x32_bf16 v[148:151], v[24:27], v[180:183], 0
    ds_read_b128 v[176:179], v5 offset:14976
    ds_read_b128 v[180:183], v5 offset:29824
    s_waitcnt lgkmcnt(3)
    v_mfma_f32_16x16x32_bf16 v[136:139], v[28:31], v[196:199], v[136:139]
    v_mfma_f32_16x16x32_bf16 v[140:143], v[32:35], v[196:199], v[140:143]
    s_waitcnt lgkmcnt(2)
    v_mfma_f32_16x16x32_bf16 v[144:147], v[28:31], v[200:203], v[144:147]
    v_mfma_f32_16x16x32_bf16 v[148:151], v[32:35], v[200:203], v[148:151]
    ds_read_b128 v[196:199], v5 offset:15040
    ds_read_b128 v[200:203], v5 offset:29888
    s_waitcnt lgkmcnt(3)
    v_mfma_f32_16x16x32_bf16 v[136:139], v[36:39], v[176:179], v[136:139]
    v_mfma_f32_16x16x32_bf16 v[140:143], v[40:43], v[176:179], v[140:143]
    s_waitcnt lgkmcnt(2)
    v_mfma_f32_16x16x32_bf16 v[144:147], v[36:39], v[180:183], v[144:147]
    v_mfma_f32_16x16x32_bf16 v[148:151], v[40:43], v[180:183], v[148:151]
    ds_read_b128 v[176:179], v5 offset:15104
    ds_read_b128 v[180:183], v5 offset:29952
    s_waitcnt lgkmcnt(3)
    v_mfma_f32_16x16x32_bf16 v[136:139], v[44:47], v[196:199], v[136:139]
    v_mfma_f32_16x16x32_bf16 v[140:143], v[48:51], v[196:199], v[140:143]
    s_waitcnt lgkmcnt(2)
    v_mfma_f32_16x16x32_bf16 v[144:147], v[44:47], v[200:203], v[144:147]
    v_mfma_f32_16x16x32_bf16 v[148:151], v[48:51], v[200:203], v[148:151]
    s_waitcnt vmcnt(0)
    s_barrier
    ds_read_b64_tr_b16 v[68:69], v252 offset:0
    ds_read_b64_tr_b16 v[70:71], v252 offset:512
    ds_read_b64_tr_b16 v[72:73], v253 offset:0
    ds_read_b64_tr_b16 v[74:75], v253 offset:512
    ds_read_b64_tr_b16 v[76:77], v252 offset:12288
    ds_read_b64_tr_b16 v[78:79], v252 offset:12800
    ds_read_b64_tr_b16 v[80:81], v253 offset:12288
    ds_read_b64_tr_b16 v[82:83], v253 offset:12800
    ds_read_b64_tr_b16 v[84:85], v252 offset:24576
    ds_read_b64_tr_b16 v[86:87], v252 offset:25088
    ds_read_b64_tr_b16 v[88:89], v253 offset:24576
    ds_read_b64_tr_b16 v[90:91], v253 offset:25088
    ds_read_b128 v[196:199], v5 offset:15168
    s_waitcnt lgkmcnt(14)
    ds_read_b128 v[200:203], v5 offset:30016
    v_mfma_f32_16x16x32_bf16 v[136:139], v[52:55], v[176:179], v[136:139]
    v_mfma_f32_16x16x32_bf16 v[140:143], v[56:59], v[176:179], v[140:143]
    s_waitcnt lgkmcnt(14)
    v_mfma_f32_16x16x32_bf16 v[144:147], v[52:55], v[180:183], v[144:147]
    v_mfma_f32_16x16x32_bf16 v[148:151], v[56:59], v[180:183], v[148:151]
    s_waitcnt lgkmcnt(11)
    ds_read_b64_tr_b16 v[92:93], v252 offset:36864
    ds_read_b64_tr_b16 v[94:95], v252 offset:37376
    ds_read_b64_tr_b16 v[96:97], v253 offset:36864
    ds_read_b64_tr_b16 v[98:99], v253 offset:37376
    s_waitcnt lgkmcnt(11)
    ds_read_b64_tr_b16 v[100:101], v252 offset:49152
    ds_read_b64_tr_b16 v[102:103], v252 offset:49664
    ds_read_b64_tr_b16 v[104:105], v253 offset:49152
    ds_read_b64_tr_b16 v[106:107], v253 offset:49664
    s_waitcnt lgkmcnt(11)
    ds_read_b64_tr_b16 v[108:109], v252 offset:61440
    ds_read_b64_tr_b16 v[110:111], v252 offset:61952
    ds_read_b64_tr_b16 v[112:113], v253 offset:61440
    ds_read_b64_tr_b16 v[114:115], v253 offset:61952
    s_waitcnt lgkmcnt(14)
    ds_read_b128 v[176:179], v5 offset:15232
    s_waitcnt lgkmcnt(14)
    ds_read_b128 v[180:183], v5 offset:30080
    v_mfma_f32_16x16x32_bf16 v[136:139], v[60:63], v[196:199], v[136:139]
    v_mfma_f32_16x16x32_bf16 v[140:143], v[64:67], v[196:199], v[140:143]
    s_waitcnt lgkmcnt(14)
    v_mfma_f32_16x16x32_bf16 v[144:147], v[60:63], v[200:203], v[144:147]
    v_mfma_f32_16x16x32_bf16 v[148:151], v[64:67], v[200:203], v[148:151]
    s_barrier
    s_add_u32 m0, s81, 0x12200
    s_nop 0
    buffer_load_dwordx4 v254, s[32:35], s82 offen lds
    s_add_u32 s82, s82, 0x380
    s_add_u32 m0, s81, 0x13200
    s_nop 0
    buffer_load_dwordx4 v254, s[32:35], s82 offen lds
    s_add_u32 s82, s82, 0x380
    s_add_u32 m0, s81, 0x14200
    s_nop 0
    buffer_load_dwordx4 v254, s[32:35], s82 offen lds
    s_add_u32 s82, s82, 0x14900
    s_add_u32 m0, s81, 0x15200
    s_nop 0
    buffer_load_dwordx4 v254, s[32:35], s82 offen lds
    s_add_u32 s82, s82, 0x380
    s_add_u32 m0, s81, 0x16200
    s_nop 0
    buffer_load_dwordx4 v254, s[32:35], s82 offen lds
    s_add_u32 s82, s82, 0x380
    s_add_u32 m0, s81, 0x17200
    s_nop 0
    buffer_load_dwordx4 v254, s[32:35], s82 offen lds
    s_add_u32 s82, s82, 0x14900
    ds_read_b128 v[196:199], v5 offset:15296
    s_waitcnt lgkmcnt(14)
    ds_read_b128 v[200:203], v5 offset:30144
    s_waitcnt lgkmcnt(3)
    v_mfma_f32_16x16x32_bf16 v[136:139], v[68:71], v[176:179], v[136:139]
    v_mfma_f32_16x16x32_bf16 v[140:143], v[72:75], v[176:179], v[140:143]
    s_waitcnt lgkmcnt(2)
    v_mfma_f32_16x16x32_bf16 v[144:147], v[68:71], v[180:183], v[144:147]
    v_mfma_f32_16x16x32_bf16 v[148:151], v[72:75], v[180:183], v[148:151]
    ds_read_b128 v[176:179], v5 offset:15360
    ds_read_b128 v[180:183], v5 offset:30208
    s_waitcnt lgkmcnt(3)
    v_mfma_f32_16x16x32_bf16 v[136:139], v[76:79], v[196:199], v[136:139]
    v_mfma_f32_16x16x32_bf16 v[140:143], v[80:83], v[196:199], v[140:143]
    s_waitcnt lgkmcnt(2)
    v_mfma_f32_16x16x32_bf16 v[144:147], v[76:79], v[200:203], v[144:147]
    v_mfma_f32_16x16x32_bf16 v[148:151], v[80:83], v[200:203], v[148:151]
    ds_read_b128 v[196:199], v5 offset:15424
    ds_read_b128 v[200:203], v5 offset:30272
    s_waitcnt lgkmcnt(3)
    v_mfma_f32_16x16x32_bf16 v[136:139], v[84:87], v[176:179], v[136:139]
    v_mfma_f32_16x16x32_bf16 v[140:143], v[88:91], v[176:179], v[140:143]
    s_waitcnt lgkmcnt(2)
    v_mfma_f32_16x16x32_bf16 v[144:147], v[84:87], v[180:183], v[144:147]
    v_mfma_f32_16x16x32_bf16 v[148:151], v[88:91], v[180:183], v[148:151]
    ds_read_b128 v[176:179], v5 offset:15488
    ds_read_b128 v[180:183], v5 offset:30336
    s_waitcnt lgkmcnt(3)
    v_mfma_f32_16x16x32_bf16 v[136:139], v[92:95], v[196:199], v[136:139]
    v_mfma_f32_16x16x32_bf16 v[140:143], v[96:99], v[196:199], v[140:143]
    s_waitcnt lgkmcnt(2)
    v_mfma_f32_16x16x32_bf16 v[144:147], v[92:95], v[200:203], v[144:147]
    v_mfma_f32_16x16x32_bf16 v[148:151], v[96:99], v[200:203], v[148:151]
    ds_read_b128 v[196:199], v5 offset:15552
    ds_read_b128 v[200:203], v5 offset:30400
    s_waitcnt lgkmcnt(3)
    v_mfma_f32_16x16x32_bf16 v[136:139], v[100:103], v[176:179], v[136:139]
    v_mfma_f32_16x16x32_bf16 v[140:143], v[104:107], v[176:179], v[140:143]
    s_waitcnt lgkmcnt(2)
    v_mfma_f32_16x16x32_bf16 v[144:147], v[100:103], v[180:183], v[144:147]
    v_mfma_f32_16x16x32_bf16 v[148:151], v[104:107], v[180:183], v[148:151]
    s_waitcnt vmcnt(0)
    s_barrier
    ds_read_b64_tr_b16 v[116:117], v252 offset:0
    ds_read_b64_tr_b16 v[118:119], v252 offset:512
    ds_read_b64_tr_b16 v[120:121], v253 offset:0
    ds_read_b64_tr_b16 v[122:123], v253 offset:512
    ds_read_b64_tr_b16 v[124:125], v252 offset:12288
    ds_read_b64_tr_b16 v[126:127], v252 offset:12800
    ds_read_b64_tr_b16 v[128:129], v253 offset:12288
    ds_read_b64_tr_b16 v[130:131], v253 offset:12800
    ds_read_b128 v[176:179], v5 offset:15616
    ds_read_b128 v[180:183], v5 offset:30464
    s_waitcnt lgkmcnt(11)
    v_mfma_f32_16x16x32_bf16 v[136:139], v[108:111], v[196:199], v[136:139]
    v_mfma_f32_16x16x32_bf16 v[140:143], v[112:115], v[196:199], v[140:143]
    s_waitcnt lgkmcnt(10)
    v_mfma_f32_16x16x32_bf16 v[144:147], v[108:111], v[200:203], v[144:147]
    v_mfma_f32_16x16x32_bf16 v[148:151], v[112:115], v[200:203], v[148:151]
    buffer_load_dwordx4 v[216:219], v8, s[36:39], s83 offen
    s_add_u32 s83, s83, 0x1c00
    buffer_load_dwordx4 v[220:223], v8, s[36:39], s83 offen
    s_add_u32 s83, s83, 0x1c00
    buffer_load_dwordx4 v[224:227], v8, s[36:39], s83 offen
    s_add_u32 s83, s83, 0x1c00
    buffer_load_dwordx4 v[228:231], v8, s[36:39], s83 offen
    s_add_u32 s83, s83, 0x1c00
    ds_read_b128 v[196:199], v5 offset:15680
    ds_read_b128 v[200:203], v5 offset:30528
    s_waitcnt lgkmcnt(3)
    v_mfma_f32_16x16x32_bf16 v[136:139], v[116:119], v[176:179], v[136:139]
    v_mfma_f32_16x16x32_bf16 v[140:143], v[120:123], v[176:179], v[140:143]
    s_waitcnt lgkmcnt(2)
    v_mfma_f32_16x16x32_bf16 v[144:147], v[116:119], v[180:183], v[144:147]
    v_mfma_f32_16x16x32_bf16 v[148:151], v[120:123], v[180:183], v[148:151]
    buffer_load_dwordx4 v[232:235], v8, s[36:39], s83 offen
    s_add_u32 s83, s83, 0x1c00
    buffer_load_dwordx4 v[236:239], v8, s[36:39], s83 offen
    s_add_u32 s83, s83, 0x1c00
    buffer_load_dwordx4 v[240:243], v8, s[36:39], s83 offen
    s_add_u32 s83, s83, 0x1c00
    buffer_load_dwordx4 v[244:247], v8, s[36:39], s83 offen
    s_add_u32 s83, s83, 0x1c00
    s_waitcnt lgkmcnt(1)
    v_mfma_f32_16x16x32_bf16 v[136:139], v[124:127], v[196:199], v[136:139]
    v_mfma_f32_16x16x32_bf16 v[140:143], v[128:131], v[196:199], v[140:143]
    s_waitcnt lgkmcnt(0)
    v_mfma_f32_16x16x32_bf16 v[144:147], v[124:127], v[200:203], v[144:147]
    v_mfma_f32_16x16x32_bf16 v[148:151], v[128:131], v[200:203], v[148:151]
    v_subrev_u32 v5, s74, v5
    s_lshl_b32 s74, s75, 12
    s_lshl_b32 s73, s73, 11
    s_add_u32 s73, s73, s74
    s_add_u32 s73, s73, 0x18200
    v_add_u32 v10, s73, v4
    v_cmp_ne_u32 vcc, 3, v3
    v_cvt_pk_bf16_f32 v176, v136, v137
    v_cvt_pk_bf16_f32 v177, v138, v139
    v_cvt_pk_bf16_f32 v178, v140, v141
    v_cvt_pk_bf16_f32 v179, v142, v143
    v_cndmask_b32 v178, 0, v178, vcc
    v_cndmask_b32 v179, 0, v179, vcc
    v_cvt_pk_bf16_f32 v180, v144, v145
    v_cvt_pk_bf16_f32 v181, v146, v147
    v_cvt_pk_bf16_f32 v182, v148, v149
    v_cvt_pk_bf16_f32 v183, v150, v151
    v_cndmask_b32 v182, 0, v182, vcc
    v_cndmask_b32 v183, 0, v183, vcc
    ds_write_b128 v10, v[176:179] offset:0
    ds_write_b128 v10, v[180:183] offset:1024
L_A_done:
    s_nop 2
    s_waitcnt lgkmcnt(0)
    s_barrier
    s_lshr_b32 s72, s70, 2
    s_and_b32 s73, s70, 3
    s_lshl_b32 s74, s70, 10
    s_add_u32 s74, s74, 0x18200
    v_add_u32 v10, s74, v4
    ds_read_b128 v[136:139], v10
    s_mul_i32 s74, s72, 5
    s_add_u32 s74, s74, s73
    s_lshl_b32 s74, s74, 10
    s_add_u32 s74, s74, 0x1a200
    v_add_u32 v10, s74, v4
    ds_read_b128 v[140:143], v10
    ds_read_b128 v[144:147], v10 offset:1024
    ds_read_b64 v[148:149], v10 offset:10240
    ds_read_b64 v[150:151], v10 offset:11264
    ds_read_b64 v[152:153], v10 offset:10248
    ds_read_b64 v[154:155], v10 offset:11272
    v_and_b32 v11, 1, v2
    v_cmp_eq_u32 s[92:93], 1, v11
    v_lshlrev_b32 v12, 2, v3
    v_sub_u32 v12, v2, v12
    v_sub_u32 v12, v12, v11
    v_cmp_le_i32 s[94:95], 0, v12
    v_cmp_le_i32 s[96:97], 2, v12
    v_mov_b32 v13, 0xc0c0100
    v_mov_b32 v14, 0x1000c0c
    v_cndmask_b32 v13, v13, v14, s[92:93]
    v_mov_b32 v14, 0xc0c0302
    v_mov_b32 v15, 0x3020c0c
    v_cndmask_b32 v14, v14, v15, s[92:93]
    v_mov_b32 v15, 0xc0c0c0c
    v_cndmask_b32 v176, v13, v15, s[94:95]
    v_cndmask_b32 v177, v14, v15, s[96:97]
    v_cndmask_b32 v178, v15, v13, s[94:95]
    v_cndmask_b32 v179, v15, v14, s[96:97]
    s_or_b32 s74, s68, s73
    s_cmp_eq_u32 s74, 0
    s_cselect_b64 s[26:27], 0, -1
    s_or_b64 s[98:99], s[94:95], s[26:27]
    s_or_b64 s[26:27], s[96:97], s[26:27]
    s_waitcnt lgkmcnt(4)
    v_mfma_f32_16x16x32_bf16 v[156:159], v[140:143], v[136:139], 0
    v_mfma_f32_16x16x32_bf16 v[160:163], v[144:147], v[136:139], 0
    s_nop 6
    v_cndmask_b32 v156, v156, v157, s[92:93]
    v_cndmask_b32 v158, v158, v159, s[92:93]
    v_cndmask_b32 v160, v160, v161, s[92:93]
    v_cndmask_b32 v162, v162, v163, s[92:93]
    v_cndmask_b32 v180, v156, v160, s[94:95]
    v_cndmask_b32 v181, v158, v162, s[96:97]
    v_mul_f32 v180, 0x3e8b97f6, v180
    v_mul_f32 v181, 0x3e8b97f6, v181
    v_mov_b32 v183, 0xceabfb8f
    v_cndmask_b32 v180, v183, v180, s[98:99]
    v_cndmask_b32 v181, v183, v181, s[26:27]
    v_max_f32 v182, v180, v181
    v_mov_b32 v183, v182
    s_nop 1
    v_permlane32_swap_b32 v182, v183
    v_max_f32 v182, v182, v183
    v_mov_b32 v183, v182
    s_nop 1
    v_permlane16_swap_b32 v182, v183
    v_max_f32 v182, v182, v183
    v_sub_f32 v180, v180, v182
    v_sub_f32 v181, v181, v182
    v_exp_f32 v180, v180
    v_exp_f32 v181, v181
    s_nop 0
    v_add_f32 v182, v180, v181
    v_mov_b32 v183, v182
    s_nop 1
    v_permlane32_swap_b32 v182, v183
    v_add_f32 v182, v182, v183
    v_mov_b32 v183, v182
    s_nop 1
    v_permlane16_swap_b32 v182, v183
    v_add_f32 v182, v182, v183
    v_rcp_f32 v182, v182
    s_nop 0
    v_mul_f32 v180, v180, v182
    v_mul_f32 v181, v181, v182
    v_cvt_pk_bf16_f32 v183, v180, v181
    v_perm_b32 v164, v183, v183, v176
    v_perm_b32 v165, v183, v183, v177
    v_perm_b32 v166, v183, v183, v178
    v_perm_b32 v167, v183, v183, v179
    s_waitcnt lgkmcnt(0)
    s_nop 0
    v_mfma_f32_16x16x32_bf16 v[168:171], v[148:151], v[164:167], 0
    v_mfma_f32_16x16x32_bf16 v[172:175], v[152:155], v[164:167], 0
    v_cmp_ne_u32 vcc, 3, v3
    s_lshl_b32 s74, s73, 4
    s_lshl_b32 s75, s69, 1
    s_add_u32 s74, s74, s75
    s_add_u32 s74, s74, s72
    s_lshl_b32 s74, s74, 10
    s_lshl_b32 s75, s68, 16
    s_add_u32 s74, s74, s75
    s_add_u32 s74, s74, 0x100000
    v_cvt_pk_bf16_f32 v156, v168, v169
    v_cvt_pk_bf16_f32 v157, v170, v171
    v_cvt_pk_bf16_f32 v158, v172, v173
    v_cvt_pk_bf16_f32 v159, v174, v175
    v_cndmask_b32 v158, 0, v158, vcc
    v_cndmask_b32 v159, 0, v159, vcc
    buffer_store_dwordx4 v[156:159], v4, s[60:63], s74 offen sc1
    s_lshr_b32 s72, s70, 1
    s_lshl_b32 s72, s72, 4
    s_add_u32 s72, s72, s100
    s_mul_i32 s72, s72, 0x380
    s_and_b32 s73, s70, 1
    s_lshl_b32 s73, s73, 6
    s_add_u32 s72, s72, s73
    s_lshl_b32 s73, s69, 7
    s_add_u32 s77, s72, s73
    v_mul_u32_u24 v7, 0x380, v2
    v_lshl_add_u32 v7, v9, 4, v7
    buffer_load_dwordx4 v[188:191], v7, s[28:31], s77 offen
    s_cmp_eq_u32 s69, 7
    s_cbranch_scc1 L_service
    s_lshl_b32 s72, s70, 13
    v_add_u32 v10, s72, v4
    s_waitcnt vmcnt(2)
    ds_write_b128 v10, v[216:219] offset:0
    ds_write_b128 v10, v[220:223] offset:1024
    ds_write_b128 v10, v[224:227] offset:2048
    ds_write_b128 v10, v[228:231] offset:3072
    ds_write_b128 v10, v[232:235] offset:4096
    ds_write_b128 v10, v[236:239] offset:5120
    ds_write_b128 v10, v[240:243] offset:6144
    ds_write_b128 v10, v[244:247] offset:7168
    s_waitcnt vmcnt(1)
    v_mov_b32 v18, 0x27200
    v_mov_b32 v19, 1
    s_mov_b64 exec, 1
    ds_add_rtn_u32 v19, v18, v19
    s_mov_b64 exec, -1
    s_waitcnt lgkmcnt(0)
    v_readfirstlane_b32 s72, v19
    s_nop 0
    s_cmp_lg_u32 s72, 7
    s_cbranch_scc1 arr_29
    s_lshl_b32 s72, s68, 7
    s_lshl_b32 s73, s69, 2
    s_add_u32 s72, s72, s73
    s_add_u32 s72, s72, 0x4000
    v_mov_b32 v18, 0
    v_mov_b32 v19, s71
    s_mov_b64 exec, 1
    buffer_store_dword v19, v18, s[60:63], s72 offen sc1
    s_mov_b64 exec, -1
arr_29:
    s_waitcnt lgkmcnt(0)
    v_lshrrev_b32 v19, 2, v1
    v_lshlrev_b32 v216, 7, v19
    v_bfe_u32 v19, v1, 3, 2
    v_lshl_add_u32 v216, v19, 5, v216
    v_and_b32 v19, 3, v1
    v_lshl_add_u32 v216, v19, 3, v216
    s_and_b32 s72, s70, 1
    s_mul_i32 s73, s72, 0x7000
    v_xor_b32 v217, 32, v216
    v_xor_b32 v218, 64, v216
    v_xor_b32 v219, 0x60, v216
    v_add_u32 v216, s73, v216
    v_add_u32 v217, s73, v217
    v_add_u32 v218, s73, v218
    v_add_u32 v219, s73, v219
    s_lshl_b32 s72, s72, 7
    s_lshl_b32 s74, s69, 8
    s_add_u32 s76, s72, s74
    v_lshlrev_b32 v16, 5, v9
    v_add_u32 v16, s76, v16
    s_mov_b32 s72, 0xe00
    buffer_load_dwordx4 v[168:171], v16, s[60:63], s72 offen sc1
    buffer_load_dwordx4 v[172:175], v16, s[60:63], s72 offen offset:16 sc1
    s_waitcnt lgkmcnt(0)
    s_barrier
    v_lshrrev_b32 v8, 3, v1
    v_and_b32 v8, 6, v8
    v_xor_b32 v8, v8, v1
    v_and_b32 v8, 7, v8
    v_lshlrev_b32 v8, 4, v8
    v_lshrrev_b32 v19, 3, v1
    s_mov_b32 s79, 0xe00
    v_mad_u32_u24 v8, v19, s79, v8
    s_add_u32 m0, s80, 0
    s_nop 0
    buffer_load_dwordx4 v8, s[40:43], s84 offen lds
    s_add_u32 m0, s80, 0x400
    s_add_u32 s79, s84, 0x7000
    buffer_load_dwordx4 v8, s[40:43], s79 offen lds
    s_add_u32 s84, s84, 0xe000
    s_add_u32 m0, s80, 0x800
    s_nop 0
    buffer_load_dwordx4 v8, s[40:43], s84 offen lds
    s_add_u32 m0, s80, 0xc00
    s_add_u32 s79, s84, 0x7000
    buffer_load_dwordx4 v8, s[40:43], s79 offen lds
    s_add_u32 s84, s84, 0xe000
    s_add_u32 m0, s80, 0x1000
    s_nop 0
    buffer_load_dwordx4 v8, s[40:43], s84 offen lds
    s_add_u32 m0, s80, 0x1400
    s_add_u32 s79, s84, 0x7000
    buffer_load_dwordx4 v8, s[40:43], s79 offen lds
    s_add_u32 s84, s84, 0xe000
    s_add_u32 m0, s80, 0x1800
    s_nop 0
    buffer_load_dwordx4 v8, s[40:43], s84 offen lds
    s_add_u32 m0, s80, 0x1c00
    s_add_u32 s79, s84, 0x7000
    buffer_load_dwordx4 v8, s[40:43], s79 offen lds
    s_add_u32 s84, s84, 0xe000
    v_lshrrev_b32 v19, 2, v1
    v_lshlrev_b32 v132, 7, v19
    v_bfe_u32 v19, v1, 3, 2
    v_lshl_add_u32 v132, v19, 5, v132
    v_and_b32 v19, 3, v1
    v_lshl_add_u32 v132, v19, 3, v132
    s_and_b32 s79, s70, 1
    s_lshl_b32 s79, s79, 6
    v_xor_b32 v132, s79, v132
    v_xor_b32 v133, 32, v132
    v_xor_b32 v134, 64, v132
    v_xor_b32 v135, 0x60, v132
    v_add_u32 v132, s80, v132
    v_add_u32 v133, s80, v133
    v_add_u32 v134, s80, v134
    v_add_u32 v135, s80, v135
    s_waitcnt vmcnt(6)
    ds_read_b64_tr_b16 v[20:21], v132 offset:0
    ds_read_b64_tr_b16 v[24:25], v133 offset:0
    ds_read_b64_tr_b16 v[28:29], v134 offset:0
    ds_read_b64_tr_b16 v[32:33], v135 offset:0
    s_waitcnt lgkmcnt(0)
    s_add_u32 m0, s80, 0
    s_nop 0
    buffer_load_dwordx4 v8, s[40:43], s84 offen lds
    s_add_u32 m0, s80, 0x400
    s_add_u32 s79, s84, 0x7000
    buffer_load_dwordx4 v8, s[40:43], s79 offen lds
    s_add_u32 s84, s84, 0xe000
    s_waitcnt vmcnt(6)
    ds_read_b64_tr_b16 v[22:23], v132 offset:2048
    ds_read_b64_tr_b16 v[26:27], v133 offset:2048
    ds_read_b64_tr_b16 v[30:31], v134 offset:2048
    ds_read_b64_tr_b16 v[34:35], v135 offset:2048
    s_waitcnt lgkmcnt(0)
    s_add_u32 m0, s80, 0x800
    s_nop 0
    buffer_load_dwordx4 v8, s[40:43], s84 offen lds
    v_xor_b32 v18, s71, v169
    v_xor_b32 v19, s71, v171
    v_or_b32 v18, v18, v19
    v_xor_b32 v19, s71, v173
    v_or_b32 v18, v18, v19
    v_xor_b32 v19, s71, v175
    v_or_b32 v18, v18, v19
    v_cmp_ne_u32 vcc, 0, v18
    s_cbranch_vccz gok_30
    s_mov_b32 s101, 0
glp_31:
    s_mov_b32 s72, 0xe00
    buffer_load_dwordx4 v[168:171], v16, s[60:63], s72 offen sc1
    buffer_load_dwordx4 v[172:175], v16, s[60:63], s72 offen offset:16 sc1
    s_add_u32 s101, s101, 1
    s_cmp_gt_u32 s101, 0x61a80
    s_cbranch_scc1 gok_30
    s_waitcnt vmcnt(0)
    v_xor_b32 v18, s71, v169
    v_xor_b32 v19, s71, v171
    v_or_b32 v18, v18, v19
    v_xor_b32 v19, s71, v173
    v_or_b32 v18, v18, v19
    v_xor_b32 v19, s71, v175
    v_or_b32 v18, v18, v19
    v_cmp_ne_u32 vcc, 0, v18
    s_cbranch_vccnz glp_31
gok_30:
    s_nop 3
    v_lshlrev_b32 v176, 16, v168
    v_and_b32 v177, 0xffff0000, v168
    v_lshlrev_b32 v178, 16, v170
    v_and_b32 v179, 0xffff0000, v170
    v_lshlrev_b32 v180, 16, v172
    v_and_b32 v181, 0xffff0000, v172
    v_lshlrev_b32 v182, 16, v174
    v_and_b32 v183, 0xffff0000, v174
    s_cmp_lg_u32 s70, 0
    s_cbranch_scc1 L_w7_skip1b
    s_lshl_b32 s72, s68, 7
    s_add_u32 s72, s72, 0x4000
    v_min_u32 v10, 7, v1
    v_lshlrev_b32 v10, 2, v10
    s_mov_b32 s101, 0
poll_32:
    buffer_load_dword v11, v10, s[60:63], s72 offen sc1
    s_add_u32 s101, s101, 1
    s_cmp_gt_u32 s101, 0x61a80
    s_cbranch_scc1 polld_33
    s_waitcnt vmcnt(0)
    v_cmp_ne_u32 vcc, s71, v11
    s_cbranch_vccnz poll_32
polld_33:
    s_waitcnt vmcnt(0)
L_w7_skip1b:
    s_nop 2
    s_waitcnt lgkmcnt(0)
    s_barrier
    s_lshl_b32 s72, s68, 16
    s_lshl_b32 s73, s70, 13
    s_add_u32 s72, s72, s73
    s_add_u32 s72, s72, 0x100000
    buffer_load_dwordx4 v[136:139], v4, s[60:63], s72 offen offset:0 sc1
    buffer_load_dwordx4 v[140:143], v4, s[60:63], s72 offen offset:1024 sc1
    buffer_load_dwordx4 v[144:147], v4, s[60:63], s72 offen offset:2048 sc1
    buffer_load_dwordx4 v[148:151], v4, s[60:63], s72 offen offset:3072 sc1
    s_add_u32 s72, s72, 0x1000
    buffer_load_dwordx4 v[152:155], v4, s[60:63], s72 offen offset:0 sc1
    buffer_load_dwordx4 v[156:159], v4, s[60:63], s72 offen offset:1024 sc1
    buffer_load_dwordx4 v[160:163], v4, s[60:63], s72 offen offset:2048 sc1
    buffer_load_dwordx4 v[164:167], v4, s[60:63], s72 offen offset:3072 sc1
    ds_read_b64_tr_b16 v[224:225], v216 offset:0
    ds_read_b64_tr_b16 v[226:227], v216 offset:2048
    ds_read_b64_tr_b16 v[228:229], v217 offset:0
    ds_read_b64_tr_b16 v[230:231], v217 offset:2048
    ds_read_b64_tr_b16 v[232:233], v218 offset:0
    ds_read_b64_tr_b16 v[234:235], v218 offset:2048
    ds_read_b64_tr_b16 v[236:237], v219 offset:0
    ds_read_b64_tr_b16 v[238:239], v219 offset:2048
    ds_read_b64_tr_b16 v[240:241], v218 offset:3584
    ds_read_b64_tr_b16 v[242:243], v218 offset:5632
    ds_read_b64_tr_b16 v[244:245], v219 offset:3584
    ds_read_b64_tr_b16 v[246:247], v219 offset:5632
    ds_read_b64_tr_b16 v[248:249], v216 offset:3584
    ds_read_b64_tr_b16 v[250:251], v216 offset:5632
    ds_read_b64_tr_b16 v[252:253], v217 offset:3584
    s_waitcnt lgkmcnt(14)
    ds_read_b64_tr_b16 v[254:255], v217 offset:5632
    s_waitcnt lgkmcnt(8)
    s_waitcnt vmcnt(7)
    v_mfma_f32_16x16x32_bf16 v[192:195], v[224:227], v[136:139], 0
    v_mfma_f32_16x16x32_bf16 v[196:199], v[228:231], v[136:139], 0
    v_mfma_f32_16x16x32_bf16 v[200:203], v[232:235], v[136:139], 0
    v_mfma_f32_16x16x32_bf16 v[204:207], v[236:239], v[136:139], 0
    ds_read_b64_tr_b16 v[224:225], v216 offset:7168
    ds_read_b64_tr_b16 v[226:227], v216 offset:9216
    ds_read_b64_tr_b16 v[228:229], v217 offset:7168
    ds_read_b64_tr_b16 v[230:231], v217 offset:9216
    ds_read_b64_tr_b16 v[232:233], v218 offset:7168
    ds_read_b64_tr_b16 v[234:235], v218 offset:9216
    ds_read_b64_tr_b16 v[236:237], v219 offset:7168
    s_waitcnt lgkmcnt(14)
    ds_read_b64_tr_b16 v[238:239], v219 offset:9216
    s_waitcnt lgkmcnt(8)
    s_waitcnt vmcnt(6)
    v_mfma_f32_16x16x32_bf16 v[192:195], v[240:243], v[140:143], v[192:195]
    v_mfma_f32_16x16x32_bf16 v[196:199], v[244:247], v[140:143], v[196:199]
    v_mfma_f32_16x16x32_bf16 v[200:203], v[248:251], v[140:143], v[200:203]
    v_mfma_f32_16x16x32_bf16 v[204:207], v[252:255], v[140:143], v[204:207]
    ds_read_b64_tr_b16 v[240:241], v218 offset:10752
    ds_read_b64_tr_b16 v[242:243], v218 offset:12800
    ds_read_b64_tr_b16 v[244:245], v219 offset:10752
    ds_read_b64_tr_b16 v[246:247], v219 offset:12800
    ds_read_b64_tr_b16 v[248:249], v216 offset:10752
    ds_read_b64_tr_b16 v[250:251], v216 offset:12800
    ds_read_b64_tr_b16 v[252:253], v217 offset:10752
    s_waitcnt lgkmcnt(14)
    ds_read_b64_tr_b16 v[254:255], v217 offset:12800
    s_waitcnt lgkmcnt(8)
    s_waitcnt vmcnt(5)
    v_mfma_f32_16x16x32_bf16 v[192:195], v[224:227], v[144:147], v[192:195]
    v_mfma_f32_16x16x32_bf16 v[196:199], v[228:231], v[144:147], v[196:199]
    v_mfma_f32_16x16x32_bf16 v[200:203], v[232:235], v[144:147], v[200:203]
    v_mfma_f32_16x16x32_bf16 v[204:207], v[236:239], v[144:147], v[204:207]
    ds_read_b64_tr_b16 v[224:225], v216 offset:14336
    ds_read_b64_tr_b16 v[226:227], v216 offset:16384
    ds_read_b64_tr_b16 v[228:229], v217 offset:14336
    ds_read_b64_tr_b16 v[230:231], v217 offset:16384
    ds_read_b64_tr_b16 v[232:233], v218 offset:14336
    ds_read_b64_tr_b16 v[234:235], v218 offset:16384
    ds_read_b64_tr_b16 v[236:237], v219 offset:14336
    s_waitcnt lgkmcnt(14)
    ds_read_b64_tr_b16 v[238:239], v219 offset:16384
    s_waitcnt lgkmcnt(8)
    s_waitcnt vmcnt(4)
    v_mfma_f32_16x16x32_bf16 v[192:195], v[240:243], v[148:151], v[192:195]
    v_mfma_f32_16x16x32_bf16 v[196:199], v[244:247], v[148:151], v[196:199]
    v_mfma_f32_16x16x32_bf16 v[200:203], v[248:251], v[148:151], v[200:203]
    v_mfma_f32_16x16x32_bf16 v[204:207], v[252:255], v[148:151], v[204:207]
    ds_read_b64_tr_b16 v[240:241], v218 offset:17920
    ds_read_b64_tr_b16 v[242:243], v218 offset:19968
    ds_read_b64_tr_b16 v[244:245], v219 offset:17920
    ds_read_b64_tr_b16 v[246:247], v219 offset:19968
    ds_read_b64_tr_b16 v[248:249], v216 offset:17920
    ds_read_b64_tr_b16 v[250:251], v216 offset:19968
    ds_read_b64_tr_b16 v[252:253], v217 offset:17920
    s_waitcnt lgkmcnt(14)
    ds_read_b64_tr_b16 v[254:255], v217 offset:19968
    s_waitcnt lgkmcnt(8)
    s_waitcnt vmcnt(3)
    v_mfma_f32_16x16x32_bf16 v[192:195], v[224:227], v[152:155], v[192:195]
    v_mfma_f32_16x16x32_bf16 v[196:199], v[228:231], v[152:155], v[196:199]
    v_mfma_f32_16x16x32_bf16 v[200:203], v[232:235], v[152:155], v[200:203]
    v_mfma_f32_16x16x32_bf16 v[204:207], v[236:239], v[152:155], v[204:207]
    ds_read_b64_tr_b16 v[224:225], v216 offset:21504
    ds_read_b64_tr_b16 v[226:227], v216 offset:23552
    ds_read_b64_tr_b16 v[228:229], v217 offset:21504
    ds_read_b64_tr_b16 v[230:231], v217 offset:23552
    ds_read_b64_tr_b16 v[232:233], v218 offset:21504
    ds_read_b64_tr_b16 v[234:235], v218 offset:23552
    ds_read_b64_tr_b16 v[236:237], v219 offset:21504
    s_waitcnt lgkmcnt(14)
    ds_read_b64_tr_b16 v[238:239], v219 offset:23552
    s_waitcnt lgkmcnt(8)
    s_waitcnt vmcnt(2)
    v_mfma_f32_16x16x32_bf16 v[192:195], v[240:243], v[156:159], v[192:195]
    v_mfma_f32_16x16x32_bf16 v[196:199], v[244:247], v[156:159], v[196:199]
    v_mfma_f32_16x16x32_bf16 v[200:203], v[248:251], v[156:159], v[200:203]
    v_mfma_f32_16x16x32_bf16 v[204:207], v[252:255], v[156:159], v[204:207]
    ds_read_b64_tr_b16 v[240:241], v218 offset:25088
    ds_read_b64_tr_b16 v[242:243], v218 offset:27136
    ds_read_b64_tr_b16 v[244:245], v219 offset:25088
    ds_read_b64_tr_b16 v[246:247], v219 offset:27136
    ds_read_b64_tr_b16 v[248:249], v216 offset:25088
    ds_read_b64_tr_b16 v[250:251], v216 offset:27136
    ds_read_b64_tr_b16 v[252:253], v217 offset:25088
    s_waitcnt lgkmcnt(14)
    ds_read_b64_tr_b16 v[254:255], v217 offset:27136
    s_waitcnt lgkmcnt(8)
    s_waitcnt vmcnt(1)
    v_mfma_f32_16x16x32_bf16 v[192:195], v[224:227], v[160:163], v[192:195]
    v_mfma_f32_16x16x32_bf16 v[196:199], v[228:231], v[160:163], v[196:199]
    v_mfma_f32_16x16x32_bf16 v[200:203], v[232:235], v[160:163], v[200:203]
    v_mfma_f32_16x16x32_bf16 v[204:207], v[236:239], v[160:163], v[204:207]
    s_waitcnt lgkmcnt(0)
    s_waitcnt vmcnt(0)
    v_mfma_f32_16x16x32_bf16 v[192:195], v[240:243], v[164:167], v[192:195]
    v_mfma_f32_16x16x32_bf16 v[196:199], v[244:247], v[164:167], v[196:199]
    v_mfma_f32_16x16x32_bf16 v[200:203], v[248:251], v[164:167], v[200:203]
    v_mfma_f32_16x16x32_bf16 v[204:207], v[252:255], v[164:167], v[204:207]
    v_add_u32 v10, s80, v4
    s_xor_b32 s72, s70, 1
    s_mul_i32 s72, s72, 0x2800
    s_add_u32 s72, s72, 0x10000
    v_add_u32 v11, s72, v4
    s_and_b32 s72, s70, 1
    s_cmp_eq_u32 s72, 0
    s_cbranch_scc1 L_B_k0
    ds_write_b128 v10, v[192:195] offset:8192
    ds_write_b128 v10, v[196:199] offset:9216
    s_waitcnt lgkmcnt(0)
    v_mov_b32 v192, v200
    v_mov_b32 v193, v201
    v_mov_b32 v194, v202
    v_mov_b32 v195, v203
    v_mov_b32 v196, v204
    v_mov_b32 v197, v205
    v_mov_b32 v198, v206
    v_mov_b32 v199, v207
    s_branch L_B_red
L_B_k0:
    s_nop 3
    ds_write_b128 v10, v[200:203] offset:8192
    ds_write_b128 v10, v[204:207] offset:9216
L_B_red:
    s_waitcnt lgkmcnt(0)
    s_barrier
    ds_read_b128 v[200:203], v11 offset:8192
    ds_read_b128 v[204:207], v11 offset:9216
    s_waitcnt lgkmcnt(0)
    v_pk_add_f32 v[192:193], v[192:193], v[200:201]
    v_pk_add_f32 v[194:195], v[194:195], v[202:203]
    v_pk_add_f32 v[196:197], v[196:197], v[204:205]
    v_pk_add_f32 v[198:199], v[198:199], v[206:207]
    s_nop 0
    v_permlane16_swap_b32 v192, v196
    v_permlane16_swap_b32 v193, v197
    v_permlane16_swap_b32 v194, v198
    v_permlane16_swap_b32 v195, v199
    v_lshlrev_b32 v154, 16, v188
    v_and_b32 v155, 0xffff0000, v188
    v_lshlrev_b32 v156, 16, v189
    v_and_b32 v157, 0xffff0000, v189
    v_lshlrev_b32 v158, 16, v190
    v_and_b32 v159, 0xffff0000, v190
    v_lshlrev_b32 v160, 16, v191
    v_and_b32 v161, 0xffff0000, v191
    v_pk_fma_f32 v[146:147], v[192:193], v[176:177], v[154:155]
    v_pk_fma_f32 v[148:149], v[194:195], v[178:179], v[156:157]
    v_pk_fma_f32 v[150:151], v[196:197], v[180:181], v[158:159]
    v_pk_fma_f32 v[152:153], v[198:199], v[182:183], v[160:161]
    v_cvt_pk_bf16_f32 v184, v146, v147
    v_cvt_pk_bf16_f32 v185, v148, v149
    v_cvt_pk_bf16_f32 v186, v150, v151
    v_cvt_pk_bf16_f32 v187, v152, v153
    s_mov_b32 s72, 0x3f803f80
    v_dot2_f32_bf16 v162, v184, s72, 0
    v_dot2_f32_bf16 v163, v184, v184, 0
    v_dot2_f32_bf16 v162, v185, s72, v162
    v_dot2_f32_bf16 v163, v185, v185, v163
    v_dot2_f32_bf16 v162, v186, s72, v162
    v_dot2_f32_bf16 v163, v186, v186, v163
    v_dot2_f32_bf16 v162, v187, s72, v162
    v_dot2_f32_bf16 v163, v187, v187, v163
    s_lshr_b32 s72, s70, 1
    s_mul_i32 s72, s72, 0x3800
    s_and_b32 s73, s70, 1
    s_lshl_b32 s74, s73, 6
    s_add_u32 s72, s72, s74
    s_lshl_b32 s74, s69, 7
    s_add_u32 s72, s72, s74
    s_lshl_b32 s74, s68, 16
    s_add_u32 s72, s72, s74
    s_add_u32 s72, s72, 0x300000
    buffer_store_dwordx4 v[184:187], v7, s[60:63], s72 offen sc1
    v_mov_b32 v13, v162
    s_nop 1
    v_permlane32_swap_b32 v162, v13
    v_add_f32 v162, v162, v13
    v_mov_b32 v13, v162
    s_nop 1
    v_permlane16_swap_b32 v162, v13
    v_add_f32 v162, v162, v13
    v_mov_b32 v14, v163
    s_nop 1
    v_permlane32_swap_b32 v163, v14
    v_add_f32 v163, v163, v14
    v_mov_b32 v14, v163
    s_nop 1
    v_permlane16_swap_b32 v163, v14
    v_add_f32 v163, v163, v14
    s_lshl_b32 s72, s69, 1
    s_add_u32 s72, s72, s73
    s_lshl_b32 s72, s72, 9
    s_lshr_b32 s73, s70, 1
    s_lshl_b32 s73, s73, 7
    s_add_u32 s72, s72, s73
    s_lshl_b32 s73, s68, 13
    s_add_u32 s72, s72, s73
    s_add_u32 s72, s72, 0x500000
    v_lshlrev_b32 v10, 3, v1
    s_mov_b64 exec, 0xffff
    buffer_store_dwordx2 v[162:163], v10, s[60:63], s72 offen sc1
    s_mov_b64 exec, -1
    s_waitcnt vmcnt(0)
    v_mov_b32 v18, 0x27204
    v_mov_b32 v19, 1
    s_mov_b64 exec, 1
    ds_add_rtn_u32 v19, v18, v19
    s_mov_b64 exec, -1
    s_waitcnt lgkmcnt(0)
    v_readfirstlane_b32 s72, v19
    s_nop 0
    s_cmp_lg_u32 s72, 7
    s_cbranch_scc1 arr_34
    s_lshl_b32 s72, s68, 7
    s_lshl_b32 s73, s69, 2
    s_add_u32 s72, s72, s73
    s_add_u32 s72, s72, 0x5000
    v_mov_b32 v18, 0
    v_mov_b32 v19, s71
    s_mov_b64 exec, 1
    buffer_store_dword v19, v18, s[60:63], s72 offen sc1
    s_mov_b64 exec, -1
arr_34:
    s_cmp_lg_u32 s70, 1
    s_cbranch_scc1 L_ngln
    v_min_u32 v16, 55, v1
    v_lshlrev_b32 v16, 5, v16
    s_mov_b32 s72, 0x1500
    buffer_load_dwordx4 v[136:139], v16, s[60:63], s72 offen sc1
    buffer_load_dwordx4 v[140:143], v16, s[60:63], s72 offen offset:16 sc1
    s_mov_b32 s72, 0x1c00
    buffer_load_dwordx4 v[144:147], v16, s[60:63], s72 offen sc1
    buffer_load_dwordx4 v[148:151], v16, s[60:63], s72 offen offset:16 sc1
    s_waitcnt vmcnt(0)
    v_xor_b32 v18, s71, v137
    v_xor_b32 v19, s71, v139
    v_or_b32 v18, v18, v19
    v_xor_b32 v19, s71, v141
    v_or_b32 v18, v18, v19
    v_xor_b32 v19, s71, v143
    v_or_b32 v18, v18, v19
    v_xor_b32 v19, s71, v145
    v_or_b32 v18, v18, v19
    v_xor_b32 v19, s71, v147
    v_or_b32 v18, v18, v19
    v_xor_b32 v19, s71, v149
    v_or_b32 v18, v18, v19
    v_xor_b32 v19, s71, v151
    v_or_b32 v18, v18, v19
    v_cmp_ne_u32 vcc, 0, v18
    s_cbranch_vccz gok_35
    s_mov_b32 s101, 0
glp_36:
    s_mov_b32 s72, 0x1500
    buffer_load_dwordx4 v[136:139], v16, s[60:63], s72 offen sc1
    buffer_load_dwordx4 v[140:143], v16, s[60:63], s72 offen offset:16 sc1
    s_mov_b32 s72, 0x1c00
    buffer_load_dwordx4 v[144:147], v16, s[60:63], s72 offen sc1
    buffer_load_dwordx4 v[148:151], v16, s[60:63], s72 offen offset:16 sc1
    s_add_u32 s101, s101, 1
    s_cmp_gt_u32 s101, 0x61a80
    s_cbranch_scc1 gok_35
    s_waitcnt vmcnt(0)
    v_xor_b32 v18, s71, v137
    v_xor_b32 v19, s71, v139
    v_or_b32 v18, v18, v19
    v_xor_b32 v19, s71, v141
    v_or_b32 v18, v18, v19
    v_xor_b32 v19, s71, v143
    v_or_b32 v18, v18, v19
    v_xor_b32 v19, s71, v145
    v_or_b32 v18, v18, v19
    v_xor_b32 v19, s71, v147
    v_or_b32 v18, v18, v19
    v_xor_b32 v19, s71, v149
    v_or_b32 v18, v18, v19
    v_xor_b32 v19, s71, v151
    v_or_b32 v18, v18, v19
    v_cmp_ne_u32 vcc, 0, v18
    s_cbranch_vccnz glp_36
gok_35:
    s_nop 3
    v_lshlrev_b32 v176, 16, v136
    v_and_b32 v177, 0xffff0000, v136
    v_lshlrev_b32 v178, 16, v138
    v_and_b32 v179, 0xffff0000, v138
    v_lshlrev_b32 v180, 16, v140
    v_and_b32 v181, 0xffff0000, v140
    v_lshlrev_b32 v182, 16, v142
    v_and_b32 v183, 0xffff0000, v142
    v_lshlrev_b32 v168, 16, v144
    v_and_b32 v169, 0xffff0000, v144
    v_lshlrev_b32 v170, 16, v146
    v_and_b32 v171, 0xffff0000, v146
    v_lshlrev_b32 v172, 16, v148
    v_and_b32 v173, 0xffff0000, v148
    v_lshlrev_b32 v174, 16, v150
    v_and_b32 v175, 0xffff0000, v150
    v_pk_add_f32 v[168:169], v[168:169], 1.0 op_sel_hi:[1,0]
    v_pk_add_f32 v[170:171], v[170:171], 1.0 op_sel_hi:[1,0]
    v_pk_add_f32 v[172:173], v[172:173], 1.0 op_sel_hi:[1,0]
    v_pk_add_f32 v[174:175], v[174:175], 1.0 op_sel_hi:[1,0]
    v_cvt_pk_bf16_f32 v18, v168, v169
    v_lshlrev_b32 v168, 16, v18
    v_and_b32 v169, 0xffff0000, v18
    v_cvt_pk_bf16_f32 v18, v170, v171
    v_lshlrev_b32 v170, 16, v18
    v_and_b32 v171, 0xffff0000, v18
    v_cvt_pk_bf16_f32 v18, v172, v173
    v_lshlrev_b32 v172, 16, v18
    v_and_b32 v173, 0xffff0000, v18
    v_cvt_pk_bf16_f32 v18, v174, v175
    v_lshlrev_b32 v174, 16, v18
    v_and_b32 v175, 0xffff0000, v18
    v_lshlrev_b32 v18, 6, v1
    v_add_u32 v18, 0x25800, v18
    ds_write_b128 v18, v[168:171] offset:0
    ds_write_b128 v18, v[172:175] offset:16
    ds_write_b128 v18, v[176:179] offset:32
    ds_write_b128 v18, v[180:183] offset:48
L_ngln:
    s_nop 0
    s_add_u32 m0, s80, 0xc00
    s_add_u32 s79, s84, 0x7000
    buffer_load_dwordx4 v8, s[40:43], s79 offen lds
    s_add_u32 s84, s84, 0xe000
    ds_read_b64_tr_b16 v[36:37], v132 offset:4096
    ds_read_b64_tr_b16 v[40:41], v133 offset:4096
    ds_read_b64_tr_b16 v[44:45], v134 offset:4096
    ds_read_b64_tr_b16 v[48:49], v135 offset:4096
    ds_read_b64_tr_b16 v[38:39], v132 offset:6144
    ds_read_b64_tr_b16 v[42:43], v133 offset:6144
    ds_read_b64_tr_b16 v[46:47], v134 offset:6144
    ds_read_b64_tr_b16 v[50:51], v135 offset:6144
    s_waitcnt lgkmcnt(4)
    s_add_u32 m0, s80, 0x1000
    s_nop 0
    buffer_load_dwordx4 v8, s[40:43], s84 offen lds
    ds_read_b64_tr_b16 v[52:53], v132 offset:0
    ds_read_b64_tr_b16 v[56:57], v133 offset:0
    ds_read_b64_tr_b16 v[60:61], v134 offset:0
    ds_read_b64_tr_b16 v[64:65], v135 offset:0
    s_add_u32 m0, s80, 0x1400
    s_add_u32 s79, s84, 0x7000
    buffer_load_dwordx4 v8, s[40:43], s79 offen lds
    s_add_u32 s84, s84, 0xe000
    s_waitcnt lgkmcnt(4)
    s_add_u32 m0, s80, 0x1800
    s_nop 0
    buffer_load_dwordx4 v8, s[40:43], s84 offen lds
    s_add_u32 m0, s80, 0x1c00
    s_add_u32 s79, s84, 0x7000
    buffer_load_dwordx4 v8, s[40:43], s79 offen lds
    s_add_u32 s84, s84, 0xe000
    s_waitcnt lgkmcnt(0)
    s_add_u32 m0, s80, 0
    s_nop 0
    buffer_load_dwordx4 v8, s[40:43], s84 offen lds
    s_add_u32 m0, s80, 0x400
    s_add_u32 s79, s84, 0x7000
    buffer_load_dwordx4 v8, s[40:43], s79 offen lds
    s_add_u32 s84, s84, 0xe000
    s_waitcnt vmcnt(6)
    ds_read_b64_tr_b16 v[54:55], v132 offset:2048
    ds_read_b64_tr_b16 v[58:59], v133 offset:2048
    ds_read_b64_tr_b16 v[62:63], v134 offset:2048
    ds_read_b64_tr_b16 v[66:67], v135 offset:2048
    s_waitcnt lgkmcnt(0)
    s_add_u32 m0, s80, 0x800
    s_nop 0
    buffer_load_dwordx4 v8, s[40:43], s84 offen lds
    s_add_u32 m0, s80, 0xc00
    s_add_u32 s79, s84, 0x7000
    buffer_load_dwordx4 v8, s[40:43], s79 offen lds
    s_add_u32 s84, s84, 0xe000
    s_waitcnt vmcnt(6)
    ds_read_b64_tr_b16 v[68:69], v132 offset:4096
    ds_read_b64_tr_b16 v[72:73], v133 offset:4096
    ds_read_b64_tr_b16 v[76:77], v134 offset:4096
    ds_read_b64_tr_b16 v[80:81], v135 offset:4096
    s_cmp_lg_u32 s70, 0
    s_cbranch_scc1 L_w7_skip2b
    s_lshl_b32 s72, s68, 7
    s_add_u32 s72, s72, 0x5000
    v_min_u32 v10, 6, v1
    v_lshlrev_b32 v10, 2, v10
    s_mov_b32 s101, 0
poll_37:
    buffer_load_dword v11, v10, s[60:63], s72 offen sc1
    s_add_u32 s101, s101, 1
    s_cmp_gt_u32 s101, 0x61a80
    s_cbranch_scc1 polld_38
    s_waitcnt vmcnt(0)
    v_cmp_ne_u32 vcc, s71, v11
    s_cbranch_vccnz poll_37
polld_38:
    s_waitcnt vmcnt(0)
L_w7_skip2b:
    s_nop 2
    s_waitcnt lgkmcnt(0)
    s_barrier
    s_lshl_b32 s72, s68, 13
    s_lshl_b32 s73, s70, 6
    s_add_u32 s72, s72, s73
    s_add_u32 s72, s72, 0x500000
    v_lshrrev_b32 v10, 2, v1
    v_lshlrev_b32 v10, 9, v10
    v_and_b32 v11, 3, v1
    v_lshl_add_u32 v10, v11, 4, v10
    v_cmp_gt_u32 vcc, 56, v1
    v_mov_b32 v11, 0x10000000
    s_nop 0
    v_cndmask_b32 v10, v11, v10, vcc
    buffer_load_dwordx4 v[188:191], v10, s[60:63], s72 offen sc1
    s_lshl_b32 s72, s68, 16
    s_mul_i32 s73, s70, 0x1c00
    s_add_u32 s72, s72, s73
    s_add_u32 s72, s72, 0x300000
    buffer_load_dwordx4 v[136:139], v6, s[60:63], s72 offen offset:0 sc1
    buffer_load_dwordx4 v[140:143], v6, s[60:63], s72 offen offset:896 sc1
    buffer_load_dwordx4 v[144:147], v6, s[60:63], s72 offen offset:1792 sc1
    buffer_load_dwordx4 v[148:151], v6, s[60:63], s72 offen offset:2688 sc1
    s_add_u32 s72, s72, 0xe00
    buffer_load_dwordx4 v[152:155], v6, s[60:63], s72 offen offset:0 sc1
    buffer_load_dwordx4 v[156:159], v6, s[60:63], s72 offen offset:896 sc1
    buffer_load_dwordx4 v[160:163], v6, s[60:63], s72 offen offset:1792 sc1
    buffer_load_dwordx4 v[164:167], v6, s[60:63], s72 offen offset:2688 sc1
    v_lshlrev_b32 v18, 6, v1
    v_add_u32 v18, 0x25800, v18
    ds_read_b128 v[168:171], v18 offset:0
    ds_read_b128 v[172:175], v18 offset:16
    ds_read_b128 v[176:179], v18 offset:32
    ds_read_b128 v[180:183], v18 offset:48
    s_waitcnt vmcnt(13)
    ds_read_b64_tr_b16 v[70:71], v132 offset:6144
    ds_read_b64_tr_b16 v[74:75], v133 offset:6144
    ds_read_b64_tr_b16 v[78:79], v134 offset:6144
    ds_read_b64_tr_b16 v[82:83], v135 offset:6144
    s_add_u32 m0, s80, 0x1000
    s_nop 0
    buffer_load_dwordx4 v8, s[40:43], s84 offen lds
    s_add_u32 m0, s80, 0x1400
    s_add_u32 s79, s84, 0x7000
    buffer_load_dwordx4 v8, s[40:43], s79 offen lds
    s_add_u32 s84, s84, 0xe000
    s_waitcnt vmcnt(13)
    ds_read_b64_tr_b16 v[84:85], v132 offset:0
    ds_read_b64_tr_b16 v[88:89], v133 offset:0
    ds_read_b64_tr_b16 v[92:93], v134 offset:0
    ds_read_b64_tr_b16 v[96:97], v135 offset:0
    s_waitcnt lgkmcnt(4)
    s_add_u32 m0, s80, 0x1800
    s_nop 0
    buffer_load_dwordx4 v8, s[40:43], s84 offen lds
    s_add_u32 m0, s80, 0x1c00
    s_add_u32 s79, s84, 0x7000
    buffer_load_dwordx4 v8, s[40:43], s79 offen lds
    s_add_u32 s84, s84, 0xe000
    s_waitcnt lgkmcnt(0)
    s_add_u32 m0, s80, 0
    s_nop 0
    buffer_load_dwordx4 v8, s[40:43], s84 offen lds
    s_waitcnt vmcnt(14)
    ds_read_b64_tr_b16 v[86:87], v132 offset:2048
    ds_read_b64_tr_b16 v[90:91], v133 offset:2048
    ds_read_b64_tr_b16 v[94:95], v134 offset:2048
    ds_read_b64_tr_b16 v[98:99], v135 offset:2048
    s_waitcnt vmcnt(13)
    v_add_f32_dpp v188, v188, v188 row_ror:4 row_mask:0xf bank_mask:0xf
    s_nop 1
    v_add_f32_dpp v188, v188, v188 row_ror:8 row_mask:0xf bank_mask:0xf
    v_add_f32_dpp v189, v189, v189 row_ror:4 row_mask:0xf bank_mask:0xf
    s_nop 1
    v_add_f32_dpp v189, v189, v189 row_ror:8 row_mask:0xf bank_mask:0xf
    v_add_f32_dpp v190, v190, v190 row_ror:4 row_mask:0xf bank_mask:0xf
    s_nop 1
    v_add_f32_dpp v190, v190, v190 row_ror:8 row_mask:0xf bank_mask:0xf
    v_add_f32_dpp v191, v191, v191 row_ror:4 row_mask:0xf bank_mask:0xf
    s_nop 1
    v_add_f32_dpp v191, v191, v191 row_ror:8 row_mask:0xf bank_mask:0xf
    v_mov_b32 v10, v188
    s_nop 1
    v_permlane32_swap_b32 v188, v10
    v_add_f32 v188, v188, v10
    v_mov_b32 v10, v188
    s_nop 1
    v_permlane16_swap_b32 v188, v10
    v_add_f32 v188, v188, v10
    v_mov_b32 v11, v189
    s_nop 1
    v_permlane32_swap_b32 v189, v11
    v_add_f32 v189, v189, v11
    v_mov_b32 v11, v189
    s_nop 1
    v_permlane16_swap_b32 v189, v11
    v_add_f32 v189, v189, v11
    v_mov_b32 v12, v190
    s_nop 1
    v_permlane32_swap_b32 v190, v12
    v_add_f32 v190, v190, v12
    v_mov_b32 v12, v190
    s_nop 1
    v_permlane16_swap_b32 v190, v12
    v_add_f32 v190, v190, v12
    v_mov_b32 v13, v191
    s_nop 1
    v_permlane32_swap_b32 v191, v13
    v_add_f32 v191, v191, v13
    v_mov_b32 v13, v191
    s_nop 1
    v_permlane16_swap_b32 v191, v13
    v_add_f32 v191, v191, v13
    s_add_u32 m0, s80, 0x400
    s_add_u32 s79, s84, 0x7000
    buffer_load_dwordx4 v8, s[40:43], s79 offen lds
    s_add_u32 s84, s84, 0xe000
    v_mul_f32 v188, 0x3b124925, v188
    v_mul_f32 v189, 0x3b124925, v189
    v_fma_f32 v189, -v188, v188, v189
    v_max_f32 v189, 0, v189
    v_cvt_pk_bf16_f32 v12, v188, v189
    v_lshlrev_b32 v10, 16, v12
    v_and_b32 v11, 0xffff0000, v12
    v_add_f32 v11, 0x3727c5ac, v11
    v_cvt_pk_bf16_f32 v12, v11, v11
    v_lshlrev_b32 v11, 16, v12
    v_sqrt_f32 v11, v11
    s_nop 0
    v_cvt_pk_bf16_f32 v12, v11, v11
    v_lshlrev_b32 v11, 16, v12
    v_rcp_f32 v188, v11
    s_nop 0
    v_mul_f32 v189, -v10, v188
    v_mul_f32 v190, 0x3b124925, v190
    v_mul_f32 v191, 0x3b124925, v191
    v_fma_f32 v191, -v190, v190, v191
    v_max_f32 v191, 0, v191
    v_cvt_pk_bf16_f32 v15, v190, v191
    v_lshlrev_b32 v13, 16, v15
    v_and_b32 v14, 0xffff0000, v15
    v_add_f32 v14, 0x3727c5ac, v14
    v_cvt_pk_bf16_f32 v15, v14, v14
    v_lshlrev_b32 v14, 16, v15
    v_sqrt_f32 v14, v14
    s_nop 0
    v_cvt_pk_bf16_f32 v15, v14, v14
    v_lshlrev_b32 v14, 16, v15
    v_rcp_f32 v190, v14
    s_nop 0
    v_mul_f32 v191, -v13, v190
    v_readlane_b32 s4, v188, 0
    v_readlane_b32 s5, v189, 0
    v_readlane_b32 s6, v190, 0
    v_readlane_b32 s7, v191, 0
    v_readlane_b32 s8, v188, 1
    v_readlane_b32 s9, v189, 1
    v_readlane_b32 s10, v190, 1
    v_readlane_b32 s11, v191, 1
    v_readlane_b32 s12, v188, 2
    v_readlane_b32 s13, v189, 2
    v_readlane_b32 s14, v190, 2
    v_readlane_b32 s15, v191, 2
    v_readlane_b32 s16, v188, 3
    v_readlane_b32 s17, v189, 3
    v_readlane_b32 s18, v190, 3
    v_readlane_b32 s19, v191, 3
    s_waitcnt lgkmcnt(0)
    s_add_u32 m0, s80, 0x800
    s_nop 0
    buffer_load_dwordx4 v8, s[40:43], s84 offen lds
    v_lshrrev_b32 v11, 2, v1
    v_lshlrev_b32 v11, 6, v11
    v_and_b32 v10, 1, v1
    v_lshl_add_u32 v11, v10, 5, v11
    v_bfe_u32 v10, v1, 1, 1
    v_lshl_add_u32 v11, v10, 3, v11
    s_mul_i32 s72, s70, 0x1d00
    v_add_u32 v11, s72, v11
    s_waitcnt lgkmcnt(0)
    s_mov_b64 exec, s[90:91]
    s_waitcnt vmcnt(14)
    v_mov_b32 v188, s5
    v_lshlrev_b32 v12, 16, v136
    v_and_b32 v13, 0xffff0000, v136
    v_lshlrev_b32 v14, 16, v137
    v_and_b32 v15, 0xffff0000, v137
    v_lshlrev_b32 v16, 16, v138
    v_and_b32 v17, 0xffff0000, v138
    v_lshlrev_b32 v18, 16, v139
    v_and_b32 v19, 0xffff0000, v139
    v_pk_fma_f32 v[12:13], v[12:13], s[4:5], v[188:189] op_sel_hi:[1,0,0]
    v_pk_fma_f32 v[14:15], v[14:15], s[4:5], v[188:189] op_sel_hi:[1,0,0]
    v_pk_fma_f32 v[16:17], v[16:17], s[4:5], v[188:189] op_sel_hi:[1,0,0]
    v_pk_fma_f32 v[18:19], v[18:19], s[4:5], v[188:189] op_sel_hi:[1,0,0]
    v_pk_fma_f32 v[12:13], v[12:13], v[168:169], v[176:177]
    v_pk_fma_f32 v[14:15], v[14:15], v[170:171], v[178:179]
    v_pk_fma_f32 v[16:17], v[16:17], v[172:173], v[180:181]
    v_pk_fma_f32 v[18:19], v[18:19], v[174:175], v[182:183]
    v_cvt_pk_bf16_f32 v136, v12, v13
    v_cvt_pk_bf16_f32 v137, v14, v15
    v_cvt_pk_bf16_f32 v138, v16, v17
    v_cvt_pk_bf16_f32 v139, v18, v19
    ds_write_b64 v11, v[136:137] offset:0
    ds_write_b64 v11, v[138:139] offset:16
    s_waitcnt vmcnt(13)
    v_mov_b32 v188, s7
    v_lshlrev_b32 v12, 16, v140
    v_and_b32 v13, 0xffff0000, v140
    v_lshlrev_b32 v14, 16, v141
    v_and_b32 v15, 0xffff0000, v141
    v_lshlrev_b32 v16, 16, v142
    v_and_b32 v17, 0xffff0000, v142
    v_lshlrev_b32 v18, 16, v143
    v_and_b32 v19, 0xffff0000, v143
    v_pk_fma_f32 v[12:13], v[12:13], s[6:7], v[188:189] op_sel_hi:[1,0,0]
    v_pk_fma_f32 v[14:15], v[14:15], s[6:7], v[188:189] op_sel_hi:[1,0,0]
    v_pk_fma_f32 v[16:17], v[16:17], s[6:7], v[188:189] op_sel_hi:[1,0,0]
    v_pk_fma_f32 v[18:19], v[18:19], s[6:7], v[188:189] op_sel_hi:[1,0,0]
    v_pk_fma_f32 v[12:13], v[12:13], v[168:169], v[176:177]
    v_pk_fma_f32 v[14:15], v[14:15], v[170:171], v[178:179]
    v_pk_fma_f32 v[16:17], v[16:17], v[172:173], v[180:181]
    v_pk_fma_f32 v[18:19], v[18:19], v[174:175], v[182:183]
    v_cvt_pk_bf16_f32 v140, v12, v13
    v_cvt_pk_bf16_f32 v141, v14, v15
    v_cvt_pk_bf16_f32 v142, v16, v17
    v_cvt_pk_bf16_f32 v143, v18, v19
    ds_write_b64 v11, v[140:141] offset:928
    ds_write_b64 v11, v[142:143] offset:944
    s_waitcnt vmcnt(12)
    v_mov_b32 v188, s9
    v_lshlrev_b32 v12, 16, v144
    v_and_b32 v13, 0xffff0000, v144
    v_lshlrev_b32 v14, 16, v145
    v_and_b32 v15, 0xffff0000, v145
    v_lshlrev_b32 v16, 16, v146
    v_and_b32 v17, 0xffff0000, v146
    v_lshlrev_b32 v18, 16, v147
    v_and_b32 v19, 0xffff0000, v147
    v_pk_fma_f32 v[12:13], v[12:13], s[8:9], v[188:189] op_sel_hi:[1,0,0]
    v_pk_fma_f32 v[14:15], v[14:15], s[8:9], v[188:189] op_sel_hi:[1,0,0]
    v_pk_fma_f32 v[16:17], v[16:17], s[8:9], v[188:189] op_sel_hi:[1,0,0]
    v_pk_fma_f32 v[18:19], v[18:19], s[8:9], v[188:189] op_sel_hi:[1,0,0]
    v_pk_fma_f32 v[12:13], v[12:13], v[168:169], v[176:177]
    v_pk_fma_f32 v[14:15], v[14:15], v[170:171], v[178:179]
    v_pk_fma_f32 v[16:17], v[16:17], v[172:173], v[180:181]
    v_pk_fma_f32 v[18:19], v[18:19], v[174:175], v[182:183]
    v_cvt_pk_bf16_f32 v144, v12, v13
    v_cvt_pk_bf16_f32 v145, v14, v15
    v_cvt_pk_bf16_f32 v146, v16, v17
    v_cvt_pk_bf16_f32 v147, v18, v19
    ds_write_b64 v11, v[144:145] offset:1856
    ds_write_b64 v11, v[146:147] offset:1872
    s_waitcnt vmcnt(11)
    v_mov_b32 v188, s11
    v_lshlrev_b32 v12, 16, v148
    v_and_b32 v13, 0xffff0000, v148
    v_lshlrev_b32 v14, 16, v149
    v_and_b32 v15, 0xffff0000, v149
    v_lshlrev_b32 v16, 16, v150
    v_and_b32 v17, 0xffff0000, v150
    v_lshlrev_b32 v18, 16, v151
    v_and_b32 v19, 0xffff0000, v151
    v_pk_fma_f32 v[12:13], v[12:13], s[10:11], v[188:189] op_sel_hi:[1,0,0]
    v_pk_fma_f32 v[14:15], v[14:15], s[10:11], v[188:189] op_sel_hi:[1,0,0]
    v_pk_fma_f32 v[16:17], v[16:17], s[10:11], v[188:189] op_sel_hi:[1,0,0]
    v_pk_fma_f32 v[18:19], v[18:19], s[10:11], v[188:189] op_sel_hi:[1,0,0]
    v_pk_fma_f32 v[12:13], v[12:13], v[168:169], v[176:177]
    v_pk_fma_f32 v[14:15], v[14:15], v[170:171], v[178:179]
    v_pk_fma_f32 v[16:17], v[16:17], v[172:173], v[180:181]
    v_pk_fma_f32 v[18:19], v[18:19], v[174:175], v[182:183]
    v_cvt_pk_bf16_f32 v148, v12, v13
    v_cvt_pk_bf16_f32 v149, v14, v15
    v_cvt_pk_bf16_f32 v150, v16, v17
    v_cvt_pk_bf16_f32 v151, v18, v19
    ds_write_b64 v11, v[148:149] offset:2784
    ds_write_b64 v11, v[150:151] offset:2800
    s_waitcnt vmcnt(10)
    v_mov_b32 v188, s13
    v_lshlrev_b32 v12, 16, v152
    v_and_b32 v13, 0xffff0000, v152
    v_lshlrev_b32 v14, 16, v153
    v_and_b32 v15, 0xffff0000, v153
    v_lshlrev_b32 v16, 16, v154
    v_and_b32 v17, 0xffff0000, v154
    v_lshlrev_b32 v18, 16, v155
    v_and_b32 v19, 0xffff0000, v155
    v_pk_fma_f32 v[12:13], v[12:13], s[12:13], v[188:189] op_sel_hi:[1,0,0]
    v_pk_fma_f32 v[14:15], v[14:15], s[12:13], v[188:189] op_sel_hi:[1,0,0]
    v_pk_fma_f32 v[16:17], v[16:17], s[12:13], v[188:189] op_sel_hi:[1,0,0]
    v_pk_fma_f32 v[18:19], v[18:19], s[12:13], v[188:189] op_sel_hi:[1,0,0]
    v_pk_fma_f32 v[12:13], v[12:13], v[168:169], v[176:177]
    v_pk_fma_f32 v[14:15], v[14:15], v[170:171], v[178:179]
    v_pk_fma_f32 v[16:17], v[16:17], v[172:173], v[180:181]
    v_pk_fma_f32 v[18:19], v[18:19], v[174:175], v[182:183]
    v_cvt_pk_bf16_f32 v152, v12, v13
    v_cvt_pk_bf16_f32 v153, v14, v15
    v_cvt_pk_bf16_f32 v154, v16, v17
    v_cvt_pk_bf16_f32 v155, v18, v19
    ds_write_b64 v11, v[152:153] offset:3712
    ds_write_b64 v11, v[154:155] offset:3728
    s_waitcnt vmcnt(9)
    v_mov_b32 v188, s15
    v_lshlrev_b32 v12, 16, v156
    v_and_b32 v13, 0xffff0000, v156
    v_lshlrev_b32 v14, 16, v157
    v_and_b32 v15, 0xffff0000, v157
    v_lshlrev_b32 v16, 16, v158
    v_and_b32 v17, 0xffff0000, v158
    v_lshlrev_b32 v18, 16, v159
    v_and_b32 v19, 0xffff0000, v159
    v_pk_fma_f32 v[12:13], v[12:13], s[14:15], v[188:189] op_sel_hi:[1,0,0]
    v_pk_fma_f32 v[14:15], v[14:15], s[14:15], v[188:189] op_sel_hi:[1,0,0]
    v_pk_fma_f32 v[16:17], v[16:17], s[14:15], v[188:189] op_sel_hi:[1,0,0]
    v_pk_fma_f32 v[18:19], v[18:19], s[14:15], v[188:189] op_sel_hi:[1,0,0]
    v_pk_fma_f32 v[12:13], v[12:13], v[168:169], v[176:177]
    v_pk_fma_f32 v[14:15], v[14:15], v[170:171], v[178:179]
    v_pk_fma_f32 v[16:17], v[16:17], v[172:173], v[180:181]
    v_pk_fma_f32 v[18:19], v[18:19], v[174:175], v[182:183]
    v_cvt_pk_bf16_f32 v156, v12, v13
    v_cvt_pk_bf16_f32 v157, v14, v15
    v_cvt_pk_bf16_f32 v158, v16, v17
    v_cvt_pk_bf16_f32 v159, v18, v19
    ds_write_b64 v11, v[156:157] offset:4640
    ds_write_b64 v11, v[158:159] offset:4656
    s_waitcnt vmcnt(8)
    v_mov_b32 v188, s17
    v_lshlrev_b32 v12, 16, v160
    v_and_b32 v13, 0xffff0000, v160
    v_lshlrev_b32 v14, 16, v161
    v_and_b32 v15, 0xffff0000, v161
    v_lshlrev_b32 v16, 16, v162
    v_and_b32 v17, 0xffff0000, v162
    v_lshlrev_b32 v18, 16, v163
    v_and_b32 v19, 0xffff0000, v163
    v_pk_fma_f32 v[12:13], v[12:13], s[16:17], v[188:189] op_sel_hi:[1,0,0]
    v_pk_fma_f32 v[14:15], v[14:15], s[16:17], v[188:189] op_sel_hi:[1,0,0]
    v_pk_fma_f32 v[16:17], v[16:17], s[16:17], v[188:189] op_sel_hi:[1,0,0]
    v_pk_fma_f32 v[18:19], v[18:19], s[16:17], v[188:189] op_sel_hi:[1,0,0]
    v_pk_fma_f32 v[12:13], v[12:13], v[168:169], v[176:177]
    v_pk_fma_f32 v[14:15], v[14:15], v[170:171], v[178:179]
    v_pk_fma_f32 v[16:17], v[16:17], v[172:173], v[180:181]
    v_pk_fma_f32 v[18:19], v[18:19], v[174:175], v[182:183]
    v_cvt_pk_bf16_f32 v160, v12, v13
    v_cvt_pk_bf16_f32 v161, v14, v15
    v_cvt_pk_bf16_f32 v162, v16, v17
    v_cvt_pk_bf16_f32 v163, v18, v19
    ds_write_b64 v11, v[160:161] offset:5568
    ds_write_b64 v11, v[162:163] offset:5584
    s_waitcnt vmcnt(7)
    v_mov_b32 v188, s19
    v_lshlrev_b32 v12, 16, v164
    v_and_b32 v13, 0xffff0000, v164
    v_lshlrev_b32 v14, 16, v165
    v_and_b32 v15, 0xffff0000, v165
    v_lshlrev_b32 v16, 16, v166
    v_and_b32 v17, 0xffff0000, v166
    v_lshlrev_b32 v18, 16, v167
    v_and_b32 v19, 0xffff0000, v167
    v_pk_fma_f32 v[12:13], v[12:13], s[18:19], v[188:189] op_sel_hi:[1,0,0]
    v_pk_fma_f32 v[14:15], v[14:15], s[18:19], v[188:189] op_sel_hi:[1,0,0]
    v_pk_fma_f32 v[16:17], v[16:17], s[18:19], v[188:189] op_sel_hi:[1,0,0]
    v_pk_fma_f32 v[18:19], v[18:19], s[18:19], v[188:189] op_sel_hi:[1,0,0]
    v_pk_fma_f32 v[12:13], v[12:13], v[168:169], v[176:177]
    v_pk_fma_f32 v[14:15], v[14:15], v[170:171], v[178:179]
    v_pk_fma_f32 v[16:17], v[16:17], v[172:173], v[180:181]
    v_pk_fma_f32 v[18:19], v[18:19], v[174:175], v[182:183]
    v_cvt_pk_bf16_f32 v164, v12, v13
    v_cvt_pk_bf16_f32 v165, v14, v15
    v_cvt_pk_bf16_f32 v166, v16, v17
    v_cvt_pk_bf16_f32 v167, v18, v19
    s_waitcnt lgkmcnt(13)
    ds_write_b64 v11, v[164:165] offset:6496
    ds_write_b64 v11, v[166:167] offset:6512
    s_mov_b64 exec, -1
    s_waitcnt lgkmcnt(0)
    s_barrier
    s_lshl_b32 s75, s69, 3
    s_add_u32 s75, s75, s70
    s_lshl_b32 s75, s75, 10
    s_lshl_b32 s73, s68, 18
    s_add_u32 s75, s75, s73
    s_add_u32 s75, s75, 0x600000
    s_and_b32 s72, s70, 1
    s_mul_i32 s72, s72, 0x1c0
    v_add_u32 v5, s72, v5
    s_mov_b32 s73, s70
    s_mul_i32 s4, s73, 0x2800
    s_add_u32 s4, s4, 0x12000
    s_lshl_b32 s72, s73, 11
    s_add_u32 s74, s72, 0x24000
    s_add_u32 s72, s72, 0xb800
    s_cmp_lt_u32 s73, 6
    s_cselect_b32 s5, s74, s72
    s_xor_b32 s73, s70, 1
    s_mul_i32 s6, s73, 0x2800
    s_add_u32 s6, s6, 0x12000
    s_lshl_b32 s72, s73, 11
    s_add_u32 s74, s72, 0x24000
    s_add_u32 s72, s72, 0xb800
    s_cmp_lt_u32 s73, 6
    s_cselect_b32 s7, s74, s72
    ds_read_b128 v[168:171], v5 offset:0
    ds_read_b128 v[172:175], v5 offset:14848
    ds_read_b128 v[176:179], v5 offset:64
    ds_read_b128 v[180:183], v5 offset:14912
    s_waitcnt lgkmcnt(3)
    v_mfma_f32_16x16x32_bf16 v[136:139], v[20:23], v[168:171], 0
    v_mfma_f32_16x16x32_bf16 v[140:143], v[24:27], v[168:171], 0
    v_mfma_f32_16x16x32_bf16 v[144:147], v[28:31], v[168:171], 0
    v_mfma_f32_16x16x32_bf16 v[148:151], v[32:35], v[168:171], 0
    s_add_u32 m0, s80, 0xc00
    s_add_u32 s79, s84, 0x7000
    buffer_load_dwordx4 v8, s[40:43], s79 offen lds
    s_add_u32 s84, s84, 0xe000
    s_waitcnt vmcnt(6)
    ds_read_b64_tr_b16 v[100:101], v132 offset:4096
    ds_read_b64_tr_b16 v[104:105], v133 offset:4096
    ds_read_b64_tr_b16 v[108:109], v134 offset:4096
    ds_read_b64_tr_b16 v[112:113], v135 offset:4096
    s_waitcnt lgkmcnt(6)
    v_mfma_f32_16x16x32_bf16 v[152:155], v[20:23], v[172:175], 0
    v_mfma_f32_16x16x32_bf16 v[156:159], v[24:27], v[172:175], 0
    v_mfma_f32_16x16x32_bf16 v[160:163], v[28:31], v[172:175], 0
    v_mfma_f32_16x16x32_bf16 v[164:167], v[32:35], v[172:175], 0
    s_waitcnt lgkmcnt(0)
    v_lshrrev_b32 v8, 3, v1
    v_and_b32 v8, 6, v8
    v_xor_b32 v8, v8, v1
    v_and_b32 v8, 7, v8
    v_lshlrev_b32 v8, 4, v8
    v_lshrrev_b32 v19, 3, v1
    s_mov_b32 s79, 0x380
    v_mad_u32_u24 v8, v19, s79, v8
    s_add_u32 m0, s80, 0x1000
    s_nop 0
    buffer_load_dwordx4 v8, s[44:47], s85 offen lds
    s_waitcnt vmcnt(5)
    ds_read_b64_tr_b16 v[102:103], v132 offset:6144
    ds_read_b64_tr_b16 v[106:107], v133 offset:6144
    ds_read_b64_tr_b16 v[110:111], v134 offset:6144
    ds_read_b64_tr_b16 v[114:115], v135 offset:6144
    ds_read_b128 v[168:171], v5 offset:128
    ds_read_b128 v[172:175], v5 offset:14976
    v_mfma_f32_16x16x32_bf16 v[136:139], v[36:39], v[176:179], v[136:139]
    v_mfma_f32_16x16x32_bf16 v[140:143], v[40:43], v[176:179], v[140:143]
    v_mfma_f32_16x16x32_bf16 v[144:147], v[44:47], v[176:179], v[144:147]
    v_mfma_f32_16x16x32_bf16 v[148:151], v[48:51], v[176:179], v[148:151]
    s_add_u32 m0, s80, 0x1400
    s_add_u32 s79, s85, 0x1c00
    buffer_load_dwordx4 v8, s[44:47], s79 offen lds
    s_add_u32 s85, s85, 0x3800
    s_waitcnt vmcnt(4)
    ds_read_b64_tr_b16 v[116:117], v132 offset:0
    ds_read_b64_tr_b16 v[120:121], v133 offset:0
    ds_read_b64_tr_b16 v[124:125], v134 offset:0
    ds_read_b64_tr_b16 v[128:129], v135 offset:0
    v_mfma_f32_16x16x32_bf16 v[152:155], v[36:39], v[180:183], v[152:155]
    v_mfma_f32_16x16x32_bf16 v[156:159], v[40:43], v[180:183], v[156:159]
    v_mfma_f32_16x16x32_bf16 v[160:163], v[44:47], v[180:183], v[160:163]
    v_mfma_f32_16x16x32_bf16 v[164:167], v[48:51], v[180:183], v[164:167]
    s_waitcnt lgkmcnt(6)
    s_add_u32 m0, s80, 0x1800
    s_nop 0
    buffer_load_dwordx4 v8, s[44:47], s85 offen lds
    ds_read_b128 v[176:179], v5 offset:192
    ds_read_b128 v[180:183], v5 offset:15040
    s_waitcnt lgkmcnt(7)
    v_mfma_f32_16x16x32_bf16 v[136:139], v[52:55], v[168:171], v[136:139]
    v_mfma_f32_16x16x32_bf16 v[140:143], v[56:59], v[168:171], v[140:143]
    v_mfma_f32_16x16x32_bf16 v[144:147], v[60:63], v[168:171], v[144:147]
    v_mfma_f32_16x16x32_bf16 v[148:151], v[64:67], v[168:171], v[148:151]
    s_add_u32 m0, s80, 0x1c00
    s_add_u32 s79, s85, 0x1c00
    buffer_load_dwordx4 v8, s[44:47], s79 offen lds
    s_add_u32 s85, s85, 0x34800
    s_cmp_eq_u32 s88, 12
    s_cselect_b32 s79, 0x188000, 0
    s_sub_u32 s85, s85, s79
    s_waitcnt lgkmcnt(6)
    v_mfma_f32_16x16x32_bf16 v[152:155], v[52:55], v[172:175], v[152:155]
    v_mfma_f32_16x16x32_bf16 v[156:159], v[56:59], v[172:175], v[156:159]
    v_mfma_f32_16x16x32_bf16 v[160:163], v[60:63], v[172:175], v[160:163]
    v_mfma_f32_16x16x32_bf16 v[164:167], v[64:67], v[172:175], v[164:167]
    s_waitcnt lgkmcnt(2)
    s_add_u32 m0, s80, 0
    s_nop 0
    buffer_load_dwordx4 v8, s[44:47], s85 offen lds
    ds_read_b128 v[168:171], v5 offset:256
    ds_read_b128 v[172:175], v5 offset:15104
    s_waitcnt lgkmcnt(3)
    v_mfma_f32_16x16x32_bf16 v[136:139], v[68:71], v[176:179], v[136:139]
    v_mfma_f32_16x16x32_bf16 v[140:143], v[72:75], v[176:179], v[140:143]
    v_mfma_f32_16x16x32_bf16 v[144:147], v[76:79], v[176:179], v[144:147]
    v_mfma_f32_16x16x32_bf16 v[148:151], v[80:83], v[176:179], v[148:151]
    s_add_u32 m0, s80, 0x400
    s_add_u32 s79, s85, 0x1c00
    buffer_load_dwordx4 v8, s[44:47], s79 offen lds
    s_add_u32 s85, s85, 0x3800
    s_waitcnt lgkmcnt(2)
    v_mfma_f32_16x16x32_bf16 v[152:155], v[68:71], v[180:183], v[152:155]
    v_mfma_f32_16x16x32_bf16 v[156:159], v[72:75], v[180:183], v[156:159]
    v_mfma_f32_16x16x32_bf16 v[160:163], v[76:79], v[180:183], v[160:163]
    v_mfma_f32_16x16x32_bf16 v[164:167], v[80:83], v[180:183], v[164:167]
    ds_read_b128 v[176:179], v5 offset:320
    ds_read_b128 v[180:183], v5 offset:15168
    s_waitcnt lgkmcnt(3)
    v_mfma_f32_16x16x32_bf16 v[136:139], v[84:87], v[168:171], v[136:139]
    v_mfma_f32_16x16x32_bf16 v[140:143], v[88:91], v[168:171], v[140:143]
    v_mfma_f32_16x16x32_bf16 v[144:147], v[92:95], v[168:171], v[144:147]
    v_mfma_f32_16x16x32_bf16 v[148:151], v[96:99], v[168:171], v[148:151]
    s_waitcnt vmcnt(6)
    ds_read_b64_tr_b16 v[118:119], v132 offset:2048
    ds_read_b64_tr_b16 v[122:123], v133 offset:2048
    ds_read_b64_tr_b16 v[126:127], v134 offset:2048
    ds_read_b64_tr_b16 v[130:131], v135 offset:2048
    s_waitcnt lgkmcnt(6)
    v_mfma_f32_16x16x32_bf16 v[152:155], v[84:87], v[172:175], v[152:155]
    v_mfma_f32_16x16x32_bf16 v[156:159], v[88:91], v[172:175], v[156:159]
    v_mfma_f32_16x16x32_bf16 v[160:163], v[92:95], v[172:175], v[160:163]
    v_mfma_f32_16x16x32_bf16 v[164:167], v[96:99], v[172:175], v[164:167]
    s_waitcnt lgkmcnt(0)
    s_add_u32 m0, s80, 0x800
    s_nop 0
    buffer_load_dwordx4 v8, s[44:47], s85 offen lds
    ds_read_b128 v[168:171], v5 offset:384
    ds_read_b128 v[172:175], v5 offset:15232
    v_mfma_f32_16x16x32_bf16 v[136:139], v[100:103], v[176:179], v[136:139]
    v_mfma_f32_16x16x32_bf16 v[140:143], v[104:107], v[176:179], v[140:143]
    v_mfma_f32_16x16x32_bf16 v[144:147], v[108:111], v[176:179], v[144:147]
    v_mfma_f32_16x16x32_bf16 v[148:151], v[112:115], v[176:179], v[148:151]
    s_add_u32 m0, s80, 0xc00
    s_add_u32 s79, s85, 0x1c00
    buffer_load_dwordx4 v8, s[44:47], s79 offen lds
    s_add_u32 s85, s85, 0x34800
    s_cmp_eq_u32 s88, 10
    s_cselect_b32 s79, 0x188000, 0
    s_sub_u32 s85, s85, s79
    v_mfma_f32_16x16x32_bf16 v[152:155], v[100:103], v[180:183], v[152:155]
    v_mfma_f32_16x16x32_bf16 v[156:159], v[104:107], v[180:183], v[156:159]
    v_mfma_f32_16x16x32_bf16 v[160:163], v[108:111], v[180:183], v[160:163]
    v_mfma_f32_16x16x32_bf16 v[164:167], v[112:115], v[180:183], v[164:167]
    v_lshrrev_b32 v19, 2, v1
    v_lshlrev_b32 v132, 7, v19
    v_bfe_u32 v19, v1, 3, 2
    v_lshl_add_u32 v132, v19, 5, v132
    v_and_b32 v19, 3, v1
    v_lshl_add_u32 v132, v19, 3, v132
    v_xor_b32 v133, 32, v132
    v_xor_b32 v134, 64, v132
    v_xor_b32 v135, 0x60, v132
    v_add_u32 v132, s80, v132
    v_add_u32 v133, s80, v133
    v_add_u32 v134, s80, v134
    v_add_u32 v135, s80, v135
    s_waitcnt vmcnt(6)
    ds_read_b64_tr_b16 v[192:193], v132 offset:4096
    ds_read_b64_tr_b16 v[196:197], v133 offset:4096
    ds_read_b64_tr_b16 v[200:201], v134 offset:4096
    ds_read_b64_tr_b16 v[204:205], v135 offset:4096
    s_waitcnt lgkmcnt(5)
    v_mfma_f32_16x16x32_bf16 v[136:139], v[116:119], v[168:171], v[136:139]
    v_mfma_f32_16x16x32_bf16 v[140:143], v[120:123], v[168:171], v[140:143]
    v_mfma_f32_16x16x32_bf16 v[144:147], v[124:127], v[168:171], v[144:147]
    v_mfma_f32_16x16x32_bf16 v[148:151], v[128:131], v[168:171], v[148:151]
    s_waitcnt lgkmcnt(0)
    s_add_u32 m0, s80, 0x1000
    s_nop 0
    buffer_load_dwordx4 v8, s[44:47], s85 offen lds
    s_waitcnt vmcnt(5)
    ds_read_b64_tr_b16 v[194:195], v132 offset:6144
    ds_read_b64_tr_b16 v[198:199], v133 offset:6144
    ds_read_b64_tr_b16 v[202:203], v134 offset:6144
    ds_read_b64_tr_b16 v[206:207], v135 offset:6144
    v_mfma_f32_16x16x32_bf16 v[152:155], v[116:119], v[172:175], v[152:155]
    v_mfma_f32_16x16x32_bf16 v[156:159], v[120:123], v[172:175], v[156:159]
    v_mfma_f32_16x16x32_bf16 v[160:163], v[124:127], v[172:175], v[160:163]
    v_mfma_f32_16x16x32_bf16 v[164:167], v[128:131], v[172:175], v[164:167]
    s_add_u32 m0, s80, 0x1400
    s_add_u32 s79, s85, 0x1c00
    buffer_load_dwordx4 v8, s[44:47], s79 offen lds
    s_add_u32 s85, s85, 0x3800
    s_cmp_lt_u32 s70, 4
    s_cbranch_scc1 pr_39
    s_setprio 1
pr_39:
    v_add_u32 v10, s4, v4
    ds_write_b128 v10, v[144:147]
    ds_write_b128 v10, v[148:151] offset:1024
    v_add_u32 v11, s5, v4
    ds_write_b128 v11, v[160:163]
    ds_write_b128 v11, v[164:167] offset:1024
    s_waitcnt lgkmcnt(0)
    s_lshl_b32 s72, s70, 2
    s_add_u32 s72, s72, 0x27240
    v_mov_b32 v18, s72
    v_mov_b32 v19, 1
    ds_write_b32 v18, v19
    s_xor_b32 s72, s70, 1
    s_lshl_b32 s72, s72, 2
    s_add_u32 s72, s72, 0x27240
    v_mov_b32 v18, s72
    s_mov_b32 s101, 0
pf_40:
    ds_read_b32 v19, v18
    s_add_u32 s101, s101, 1
    s_cmp_gt_u32 s101, 0x3d0900
    s_cbranch_scc1 pfd_41
    s_waitcnt lgkmcnt(0)
    v_readfirstlane_b32 s72, v19
    s_nop 0
    s_cmp_lt_u32 s72, 1
    s_cbranch_scc1 pf_40
pfd_41:
    s_waitcnt lgkmcnt(0)
    v_add_u32 v10, s6, v4
    ds_read_b128 v[144:147], v10
    ds_read_b128 v[148:151], v10 offset:1024
    v_add_u32 v11, s7, v4
    ds_read_b128 v[160:163], v11
    ds_read_b128 v[164:167], v11 offset:1024
    s_waitcnt lgkmcnt(0)
    s_lshl_b32 s72, s70, 2
    s_add_u32 s72, s72, 0x27240
    v_mov_b32 v18, s72
    v_mov_b32 v19, 2
    ds_write_b32 v18, v19
    ds_read_b128 v[168:171], v5 offset:29696
    ds_read_b128 v[172:175], v5 offset:44544
    v_pk_add_f32 v[136:137], v[136:137], v[144:145]
    v_pk_add_f32 v[138:139], v[138:139], v[146:147]
    v_pk_add_f32 v[140:141], v[140:141], v[148:149]
    v_pk_add_f32 v[142:143], v[142:143], v[150:151]
    v_pk_add_f32 v[152:153], v[152:153], v[160:161]
    v_pk_add_f32 v[154:155], v[154:155], v[162:163]
    v_pk_add_f32 v[156:157], v[156:157], v[164:165]
    v_pk_add_f32 v[158:159], v[158:159], v[166:167]
    v_mul_f32 v10, 0xbfb8aa3b, v136
    v_exp_f32 v10, v10
    v_mul_f32 v11, 0xbfb8aa3b, v137
    v_exp_f32 v11, v11
    v_mul_f32 v12, 0xbfb8aa3b, v138
    v_exp_f32 v12, v12
    v_mul_f32 v13, 0xbfb8aa3b, v139
    v_exp_f32 v13, v13
    v_mul_f32 v14, 0xbfb8aa3b, v140
    v_exp_f32 v14, v14
    v_mul_f32 v15, 0xbfb8aa3b, v141
    v_exp_f32 v15, v15
    v_mul_f32 v16, 0xbfb8aa3b, v142
    v_exp_f32 v16, v16
    v_mul_f32 v17, 0xbfb8aa3b, v143
    v_exp_f32 v17, v17
    v_add_f32 v10, 1.0, v10
    v_rcp_f32 v10, v10
    v_add_f32 v11, 1.0, v11
    v_rcp_f32 v11, v11
    v_add_f32 v12, 1.0, v12
    v_rcp_f32 v12, v12
    v_add_f32 v13, 1.0, v13
    v_rcp_f32 v13, v13
    v_add_f32 v14, 1.0, v14
    v_rcp_f32 v14, v14
    v_add_f32 v15, 1.0, v15
    v_rcp_f32 v15, v15
    v_add_f32 v16, 1.0, v16
    v_rcp_f32 v16, v16
    v_add_f32 v17, 1.0, v17
    v_rcp_f32 v17, v17
    v_mul_f32 v136, v136, v10
    v_mul_f32 v137, v137, v11
    v_mul_f32 v138, v138, v12
    v_mul_f32 v139, v139, v13
    v_mul_f32 v140, v140, v14
    v_mul_f32 v141, v141, v15
    v_mul_f32 v142, v142, v16
    v_mul_f32 v143, v143, v17
    v_cvt_pk_bf16_f32 v144, v136, v137
    v_cvt_pk_bf16_f32 v145, v138, v139
    v_cvt_pk_bf16_f32 v146, v140, v141
    v_cvt_pk_bf16_f32 v147, v142, v143
    buffer_store_dwordx4 v[144:147], v4, s[60:63], s75 offen sc1
    s_add_u32 s75, s75, 0xe000
    v_mov_b32 v188, v144
    v_mov_b32 v189, v145
    v_mov_b32 v190, v146
    v_mov_b32 v191, v147
    s_add_u32 m0, s80, 0x1800
    s_nop 0
    buffer_load_dwordx4 v8, s[44:47], s85 offen lds
    s_waitcnt vmcnt(6)
    ds_read_b64_tr_b16 v[208:209], v132 offset:0
    ds_read_b64_tr_b16 v[212:213], v133 offset:0
    ds_read_b64_tr_b16 v[216:217], v134 offset:0
    ds_read_b64_tr_b16 v[220:221], v135 offset:0
    v_mul_f32 v10, 0xbfb8aa3b, v152
    v_exp_f32 v10, v10
    v_mul_f32 v11, 0xbfb8aa3b, v153
    v_exp_f32 v11, v11
    v_mul_f32 v12, 0xbfb8aa3b, v154
    v_exp_f32 v12, v12
    v_mul_f32 v13, 0xbfb8aa3b, v155
    v_exp_f32 v13, v13
    v_mul_f32 v14, 0xbfb8aa3b, v156
    v_exp_f32 v14, v14
    v_mul_f32 v15, 0xbfb8aa3b, v157
    v_exp_f32 v15, v15
    v_mul_f32 v16, 0xbfb8aa3b, v158
    v_exp_f32 v16, v16
    v_mul_f32 v17, 0xbfb8aa3b, v159
    v_exp_f32 v17, v17
    v_add_f32 v10, 1.0, v10
    v_rcp_f32 v10, v10
    v_add_f32 v11, 1.0, v11
    v_rcp_f32 v11, v11
    v_add_f32 v12, 1.0, v12
    v_rcp_f32 v12, v12
    v_add_f32 v13, 1.0, v13
    v_rcp_f32 v13, v13
    v_add_f32 v14, 1.0, v14
    v_rcp_f32 v14, v14
    v_add_f32 v15, 1.0, v15
    v_rcp_f32 v15, v15
    v_add_f32 v16, 1.0, v16
    v_rcp_f32 v16, v16
    v_add_f32 v17, 1.0, v17
    v_rcp_f32 v17, v17
    v_mul_f32 v152, v152, v10
    v_mul_f32 v153, v153, v11
    v_mul_f32 v154, v154, v12
    v_mul_f32 v155, v155, v13
    v_mul_f32 v156, v156, v14
    v_mul_f32 v157, v157, v15
    v_mul_f32 v158, v158, v16
    v_mul_f32 v159, v159, v17
    v_cvt_pk_bf16_f32 v160, v152, v153
    v_cvt_pk_bf16_f32 v161, v154, v155
    v_cvt_pk_bf16_f32 v162, v156, v157
    v_cvt_pk_bf16_f32 v163, v158, v159
    buffer_store_dwordx4 v[160:163], v4, s[60:63], s75 offen sc1
    s_add_u32 s75, s75, 0xe000
    s_add_u32 m0, s80, 0x1c00
    s_add_u32 s79, s85, 0x1c00
    buffer_load_dwordx4 v8, s[44:47], s79 offen lds
    s_add_u32 s85, s85, 0x34800
    s_cmp_eq_u32 s88, 8
    s_cselect_b32 s79, 0x188000, 0
    s_sub_u32 s85, s85, s79
    s_waitcnt vmcnt(6)
    ds_read_b64_tr_b16 v[210:211], v132 offset:2048
    ds_read_b64_tr_b16 v[214:215], v133 offset:2048
    ds_read_b64_tr_b16 v[218:219], v134 offset:2048
    ds_read_b64_tr_b16 v[222:223], v135 offset:2048
    ds_read_b128 v[176:179], v5 offset:29760
    ds_read_b128 v[180:183], v5 offset:44608
    s_waitcnt lgkmcnt(11)
    v_mfma_f32_16x16x32_bf16 v[136:139], v[20:23], v[168:171], 0
    v_mfma_f32_16x16x32_bf16 v[140:143], v[24:27], v[168:171], 0
    v_mfma_f32_16x16x32_bf16 v[144:147], v[28:31], v[168:171], 0
    v_mfma_f32_16x16x32_bf16 v[148:151], v[32:35], v[168:171], 0
    s_waitcnt lgkmcnt(6)
    s_add_u32 m0, s80, 0
    s_nop 0
    buffer_load_dwordx4 v8, s[44:47], s85 offen lds
    v_mfma_f32_16x16x32_bf16 v[152:155], v[20:23], v[172:175], 0
    v_mfma_f32_16x16x32_bf16 v[156:159], v[24:27], v[172:175], 0
    v_mfma_f32_16x16x32_bf16 v[160:163], v[28:31], v[172:175], 0
    v_mfma_f32_16x16x32_bf16 v[164:167], v[32:35], v[172:175], 0
    ds_read_b128 v[168:171], v5 offset:29824
    ds_read_b128 v[172:175], v5 offset:44672
    s_waitcnt lgkmcnt(3)
    v_mfma_f32_16x16x32_bf16 v[136:139], v[36:39], v[176:179], v[136:139]
    v_mfma_f32_16x16x32_bf16 v[140:143], v[40:43], v[176:179], v[140:143]
    v_mfma_f32_16x16x32_bf16 v[144:147], v[44:47], v[176:179], v[144:147]
    v_mfma_f32_16x16x32_bf16 v[148:151], v[48:51], v[176:179], v[148:151]
    s_add_u32 m0, s80, 0x400
    s_add_u32 s79, s85, 0x1c00
    buffer_load_dwordx4 v8, s[44:47], s79 offen lds
    s_add_u32 s85, s85, 0x3800
    s_waitcnt vmcnt(6)
    ds_read_b64_tr_b16 v[224:225], v132 offset:4096
    ds_read_b64_tr_b16 v[228:229], v133 offset:4096
    ds_read_b64_tr_b16 v[232:233], v134 offset:4096
    ds_read_b64_tr_b16 v[236:237], v135 offset:4096
    s_waitcnt lgkmcnt(6)
    v_mfma_f32_16x16x32_bf16 v[152:155], v[36:39], v[180:183], v[152:155]
    v_mfma_f32_16x16x32_bf16 v[156:159], v[40:43], v[180:183], v[156:159]
    v_mfma_f32_16x16x32_bf16 v[160:163], v[44:47], v[180:183], v[160:163]
    v_mfma_f32_16x16x32_bf16 v[164:167], v[48:51], v[180:183], v[164:167]
    s_add_u32 m0, s80, 0x800
    s_nop 0
    buffer_load_dwordx4 v8, s[44:47], s85 offen lds
    ds_read_b128 v[176:179], v5 offset:29888
    ds_read_b128 v[180:183], v5 offset:44736
    s_waitcnt lgkmcnt(7)
    v_mfma_f32_16x16x32_bf16 v[136:139], v[52:55], v[168:171], v[136:139]
    v_mfma_f32_16x16x32_bf16 v[140:143], v[56:59], v[168:171], v[140:143]
    v_mfma_f32_16x16x32_bf16 v[144:147], v[60:63], v[168:171], v[144:147]
    v_mfma_f32_16x16x32_bf16 v[148:151], v[64:67], v[168:171], v[148:151]
    s_add_u32 m0, s80, 0xc00
    s_add_u32 s79, s85, 0x1c00
    buffer_load_dwordx4 v8, s[44:47], s79 offen lds
    s_add_u32 s85, s85, 0x34800
    s_cmp_eq_u32 s88, 6
    s_cselect_b32 s79, 0x188000, 0
    s_sub_u32 s85, s85, s79
    s_waitcnt lgkmcnt(6)
    v_mfma_f32_16x16x32_bf16 v[152:155], v[52:55], v[172:175], v[152:155]
    v_mfma_f32_16x16x32_bf16 v[156:159], v[56:59], v[172:175], v[156:159]
    v_mfma_f32_16x16x32_bf16 v[160:163], v[60:63], v[172:175], v[160:163]
    v_mfma_f32_16x16x32_bf16 v[164:167], v[64:67], v[172:175], v[164:167]
    s_waitcnt lgkmcnt(2)
    s_add_u32 m0, s80, 0x1000
    s_nop 0
    buffer_load_dwordx4 v8, s[44:47], s85 offen lds
    ds_read_b128 v[168:171], v5 offset:29952
    ds_read_b128 v[172:175], v5 offset:44800
    s_waitcnt lgkmcnt(3)
    v_mfma_f32_16x16x32_bf16 v[136:139], v[68:71], v[176:179], v[136:139]
    v_mfma_f32_16x16x32_bf16 v[140:143], v[72:75], v[176:179], v[140:143]
    v_mfma_f32_16x16x32_bf16 v[144:147], v[76:79], v[176:179], v[144:147]
    v_mfma_f32_16x16x32_bf16 v[148:151], v[80:83], v[176:179], v[148:151]
    s_add_u32 m0, s80, 0x1400
    s_add_u32 s79, s85, 0x1c00
    buffer_load_dwordx4 v8, s[44:47], s79 offen lds
    s_add_u32 s85, s85, 0x3800
    s_waitcnt lgkmcnt(2)
    v_mfma_f32_16x16x32_bf16 v[152:155], v[68:71], v[180:183], v[152:155]
    v_mfma_f32_16x16x32_bf16 v[156:159], v[72:75], v[180:183], v[156:159]
    v_mfma_f32_16x16x32_bf16 v[160:163], v[76:79], v[180:183], v[160:163]
    v_mfma_f32_16x16x32_bf16 v[164:167], v[80:83], v[180:183], v[164:167]
    ds_read_b128 v[176:179], v5 offset:30016
    ds_read_b128 v[180:183], v5 offset:44864
    s_waitcnt lgkmcnt(3)
    v_mfma_f32_16x16x32_bf16 v[136:139], v[84:87], v[168:171], v[136:139]
    v_mfma_f32_16x16x32_bf16 v[140:143], v[88:91], v[168:171], v[140:143]
    v_mfma_f32_16x16x32_bf16 v[144:147], v[92:95], v[168:171], v[144:147]
    v_mfma_f32_16x16x32_bf16 v[148:151], v[96:99], v[168:171], v[148:151]
    s_waitcnt vmcnt(6)
    ds_read_b64_tr_b16 v[226:227], v132 offset:6144
    ds_read_b64_tr_b16 v[230:231], v133 offset:6144
    ds_read_b64_tr_b16 v[234:235], v134 offset:6144
    ds_read_b64_tr_b16 v[238:239], v135 offset:6144
    s_waitcnt lgkmcnt(6)
    v_mfma_f32_16x16x32_bf16 v[152:155], v[84:87], v[172:175], v[152:155]
    v_mfma_f32_16x16x32_bf16 v[156:159], v[88:91], v[172:175], v[156:159]
    v_mfma_f32_16x16x32_bf16 v[160:163], v[92:95], v[172:175], v[160:163]
    v_mfma_f32_16x16x32_bf16 v[164:167], v[96:99], v[172:175], v[164:167]
    s_waitcnt lgkmcnt(0)
    s_add_u32 m0, s80, 0x1800
    s_nop 0
    buffer_load_dwordx4 v8, s[44:47], s85 offen lds
    ds_read_b128 v[168:171], v5 offset:30080
    ds_read_b128 v[172:175], v5 offset:44928
    v_mfma_f32_16x16x32_bf16 v[136:139], v[100:103], v[176:179], v[136:139]
    v_mfma_f32_16x16x32_bf16 v[140:143], v[104:107], v[176:179], v[140:143]
    v_mfma_f32_16x16x32_bf16 v[144:147], v[108:111], v[176:179], v[144:147]
    v_mfma_f32_16x16x32_bf16 v[148:151], v[112:115], v[176:179], v[148:151]
    s_add_u32 m0, s80, 0x1c00
    s_add_u32 s79, s85, 0x1c00
    buffer_load_dwordx4 v8, s[44:47], s79 offen lds
    s_add_u32 s85, s85, 0x34800
    s_cmp_eq_u32 s88, 4
    s_cselect_b32 s79, 0x188000, 0
    s_sub_u32 s85, s85, s79
    v_mfma_f32_16x16x32_bf16 v[152:155], v[100:103], v[180:183], v[152:155]
    v_mfma_f32_16x16x32_bf16 v[156:159], v[104:107], v[180:183], v[156:159]
    v_mfma_f32_16x16x32_bf16 v[160:163], v[108:111], v[180:183], v[160:163]
    v_mfma_f32_16x16x32_bf16 v[164:167], v[112:115], v[180:183], v[164:167]
    s_waitcnt vmcnt(6)
    ds_read_b64_tr_b16 v[240:241], v132 offset:0
    ds_read_b64_tr_b16 v[244:245], v133 offset:0
    ds_read_b64_tr_b16 v[248:249], v134 offset:0
    ds_read_b64_tr_b16 v[252:253], v135 offset:0
    v_mov_b32 v18, 0x27208
    v_mov_b32 v19, 1
    s_mov_b64 exec, 1
    ds_add_rtn_u32 v19, v18, v19
    s_mov_b64 exec, -1
    s_waitcnt lgkmcnt(0)
    v_readfirstlane_b32 s72, v19
    s_nop 0
    s_cmp_lg_u32 s72, 7
    s_cbranch_scc1 arr_42
    s_lshl_b32 s72, s68, 7
    s_lshl_b32 s73, s69, 2
    s_add_u32 s72, s72, s73
    s_add_u32 s72, s72, 0x6000
    v_mov_b32 v18, 0
    v_mov_b32 v19, s71
    s_mov_b64 exec, 1
    buffer_store_dword v19, v18, s[60:63], s72 offen sc1
    s_mov_b64 exec, -1
arr_42:
    v_mfma_f32_16x16x32_bf16 v[136:139], v[116:119], v[168:171], v[136:139]
    v_mfma_f32_16x16x32_bf16 v[140:143], v[120:123], v[168:171], v[140:143]
    v_mfma_f32_16x16x32_bf16 v[144:147], v[124:127], v[168:171], v[144:147]
    v_mfma_f32_16x16x32_bf16 v[148:151], v[128:131], v[168:171], v[148:151]
    s_add_u32 m0, s80, 0
    s_nop 0
    buffer_load_dwordx4 v8, s[44:47], s85 offen lds
    v_mfma_f32_16x16x32_bf16 v[152:155], v[116:119], v[172:175], v[152:155]
    v_mfma_f32_16x16x32_bf16 v[156:159], v[120:123], v[172:175], v[156:159]
    v_mfma_f32_16x16x32_bf16 v[160:163], v[124:127], v[172:175], v[160:163]
    v_mfma_f32_16x16x32_bf16 v[164:167], v[128:131], v[172:175], v[164:167]
    s_waitcnt vmcnt(5)
    ds_read_b64_tr_b16 v[242:243], v132 offset:2048
    ds_read_b64_tr_b16 v[246:247], v133 offset:2048
    ds_read_b64_tr_b16 v[250:251], v134 offset:2048
    ds_read_b64_tr_b16 v[254:255], v135 offset:2048
    s_xor_b32 s72, s70, 1
    s_lshl_b32 s72, s72, 2
    s_add_u32 s72, s72, 0x27240
    v_mov_b32 v18, s72
    s_mov_b32 s101, 0
pf_43:
    ds_read_b32 v19, v18
    s_add_u32 s101, s101, 1
    s_cmp_gt_u32 s101, 0x3d0900
    s_cbranch_scc1 pfd_44
    s_waitcnt lgkmcnt(0)
    v_readfirstlane_b32 s72, v19
    s_nop 0
    s_cmp_lt_u32 s72, 2
    s_cbranch_scc1 pf_43
pfd_44:
    s_waitcnt lgkmcnt(0)
    v_add_u32 v10, s4, v4
    ds_write_b128 v10, v[144:147]
    ds_write_b128 v10, v[148:151] offset:1024
    v_add_u32 v11, s5, v4
    ds_write_b128 v11, v[160:163]
    ds_write_b128 v11, v[164:167] offset:1024
    s_waitcnt lgkmcnt(0)
    s_lshl_b32 s72, s70, 2
    s_add_u32 s72, s72, 0x27240
    v_mov_b32 v18, s72
    v_mov_b32 v19, 3
    ds_write_b32 v18, v19
    s_xor_b32 s72, s70, 1
    s_lshl_b32 s72, s72, 2
    s_add_u32 s72, s72, 0x27240
    v_mov_b32 v18, s72
    s_mov_b32 s101, 0
pf_45:
    ds_read_b32 v19, v18
    s_add_u32 s101, s101, 1
    s_cmp_gt_u32 s101, 0x3d0900
    s_cbranch_scc1 pfd_46
    s_waitcnt lgkmcnt(0)
    v_readfirstlane_b32 s72, v19
    s_nop 0
    s_cmp_lt_u32 s72, 3
    s_cbranch_scc1 pf_45
pfd_46:
    s_waitcnt lgkmcnt(0)
    v_add_u32 v10, s6, v4
    ds_read_b128 v[144:147], v10
    ds_read_b128 v[148:151], v10 offset:1024
    v_add_u32 v11, s7, v4
    ds_read_b128 v[160:163], v11
    ds_read_b128 v[164:167], v11 offset:1024
    s_waitcnt lgkmcnt(0)
    v_pk_add_f32 v[136:137], v[136:137], v[144:145]
    v_pk_add_f32 v[138:139], v[138:139], v[146:147]
    v_pk_add_f32 v[140:141], v[140:141], v[148:149]
    v_pk_add_f32 v[142:143], v[142:143], v[150:151]
    v_pk_add_f32 v[152:153], v[152:153], v[160:161]
    v_pk_add_f32 v[154:155], v[154:155], v[162:163]
    v_pk_add_f32 v[156:157], v[156:157], v[164:165]
    v_pk_add_f32 v[158:159], v[158:159], v[166:167]
    v_mul_f32 v10, 0xbfb8aa3b, v136
    v_exp_f32 v10, v10
    v_mul_f32 v11, 0xbfb8aa3b, v137
    v_exp_f32 v11, v11
    v_mul_f32 v12, 0xbfb8aa3b, v138
    v_exp_f32 v12, v12
    v_mul_f32 v13, 0xbfb8aa3b, v139
    v_exp_f32 v13, v13
    v_mul_f32 v14, 0xbfb8aa3b, v140
    v_exp_f32 v14, v14
    v_mul_f32 v15, 0xbfb8aa3b, v141
    v_exp_f32 v15, v15
    v_mul_f32 v16, 0xbfb8aa3b, v142
    v_exp_f32 v16, v16
    v_mul_f32 v17, 0xbfb8aa3b, v143
    v_exp_f32 v17, v17
    v_add_f32 v10, 1.0, v10
    v_rcp_f32 v10, v10
    v_add_f32 v11, 1.0, v11
    v_rcp_f32 v11, v11
    v_add_f32 v12, 1.0, v12
    v_rcp_f32 v12, v12
    v_add_f32 v13, 1.0, v13
    v_rcp_f32 v13, v13
    v_add_f32 v14, 1.0, v14
    v_rcp_f32 v14, v14
    v_add_f32 v15, 1.0, v15
    v_rcp_f32 v15, v15
    v_add_f32 v16, 1.0, v16
    v_rcp_f32 v16, v16
    v_add_f32 v17, 1.0, v17
    v_rcp_f32 v17, v17
    v_mul_f32 v136, v136, v10
    v_mul_f32 v137, v137, v11
    v_mul_f32 v138, v138, v12
    v_mul_f32 v139, v139, v13
    v_mul_f32 v140, v140, v14
    v_mul_f32 v141, v141, v15
    v_mul_f32 v142, v142, v16
    v_mul_f32 v143, v143, v17
    v_cvt_pk_bf16_f32 v144, v136, v137
    v_cvt_pk_bf16_f32 v145, v138, v139
    v_cvt_pk_bf16_f32 v146, v140, v141
    v_cvt_pk_bf16_f32 v147, v142, v143
    buffer_store_dwordx4 v[144:147], v4, s[60:63], s75 offen sc1
    s_add_u32 s75, s75, 0xe000
    s_add_u32 m0, s80, 0x400
    s_add_u32 s79, s85, 0x1c00
    buffer_load_dwordx4 v8, s[44:47], s79 offen lds
    s_add_u32 s85, s85, 0x3800
    s_waitcnt vmcnt(5)
    ds_read_b64_tr_b16 v[20:21], v132 offset:4096
    ds_read_b64_tr_b16 v[24:25], v133 offset:4096
    ds_read_b64_tr_b16 v[28:29], v134 offset:4096
    ds_read_b64_tr_b16 v[32:33], v135 offset:4096
    v_mul_f32 v10, 0xbfb8aa3b, v152
    v_exp_f32 v10, v10
    v_mul_f32 v11, 0xbfb8aa3b, v153
    v_exp_f32 v11, v11
    v_mul_f32 v12, 0xbfb8aa3b, v154
    v_exp_f32 v12, v12
    v_mul_f32 v13, 0xbfb8aa3b, v155
    v_exp_f32 v13, v13
    v_mul_f32 v14, 0xbfb8aa3b, v156
    v_exp_f32 v14, v14
    v_mul_f32 v15, 0xbfb8aa3b, v157
    v_exp_f32 v15, v15
    v_mul_f32 v16, 0xbfb8aa3b, v158
    v_exp_f32 v16, v16
    v_mul_f32 v17, 0xbfb8aa3b, v159
    v_exp_f32 v17, v17
    v_add_f32 v10, 1.0, v10
    v_rcp_f32 v10, v10
    v_add_f32 v11, 1.0, v11
    v_rcp_f32 v11, v11
    v_add_f32 v12, 1.0, v12
    v_rcp_f32 v12, v12
    v_add_f32 v13, 1.0, v13
    v_rcp_f32 v13, v13
    v_add_f32 v14, 1.0, v14
    v_rcp_f32 v14, v14
    v_add_f32 v15, 1.0, v15
    v_rcp_f32 v15, v15
    v_add_f32 v16, 1.0, v16
    v_rcp_f32 v16, v16
    v_add_f32 v17, 1.0, v17
    v_rcp_f32 v17, v17
    v_mul_f32 v152, v152, v10
    v_mul_f32 v153, v153, v11
    v_mul_f32 v154, v154, v12
    v_mul_f32 v155, v155, v13
    v_mul_f32 v156, v156, v14
    v_mul_f32 v157, v157, v15
    v_mul_f32 v158, v158, v16
    v_mul_f32 v159, v159, v17
    v_cvt_pk_bf16_f32 v160, v152, v153
    v_cvt_pk_bf16_f32 v161, v154, v155
    v_cvt_pk_bf16_f32 v162, v156, v157
    v_cvt_pk_bf16_f32 v163, v158, v159
    buffer_store_dwordx4 v[160:163], v4, s[60:63], s75 offen sc1
    s_add_u32 s75, s75, 0xe000
    s_add_u32 m0, s80, 0x800
    s_nop 0
    buffer_load_dwordx4 v8, s[44:47], s85 offen lds
    s_waitcnt vmcnt(5)
    ds_read_b64_tr_b16 v[22:23], v132 offset:6144
    ds_read_b64_tr_b16 v[26:27], v133 offset:6144
    ds_read_b64_tr_b16 v[30:31], v134 offset:6144
    ds_read_b64_tr_b16 v[34:35], v135 offset:6144
    s_cmp_lt_u32 s70, 4
    s_cbranch_scc1 pr_47
    s_setprio 0
pr_47:
    s_lshl_b32 s75, s70, 10
    s_lshl_b32 s73, s68, 18
    s_add_u32 s75, s75, s73
    s_add_u32 s75, s75, 0x600000
    s_mov_b32 s72, s69
    s_lshl_b32 s4, s72, 13
    s_add_u32 s4, s4, s75
    s_add_u32 s72, s72, 1
    s_cmp_eq_u32 s72, 7
    s_cselect_b32 s72, 0, s72
    s_lshl_b32 s5, s72, 13
    s_add_u32 s5, s5, s75
    s_add_u32 s72, s72, 1
    s_cmp_eq_u32 s72, 7
    s_cselect_b32 s72, 0, s72
    s_lshl_b32 s6, s72, 13
    s_add_u32 s6, s6, s75
    s_add_u32 s72, s72, 1
    s_cmp_eq_u32 s72, 7
    s_cselect_b32 s72, 0, s72
    s_lshl_b32 s7, s72, 13
    s_add_u32 s7, s7, s75
    s_add_u32 s72, s72, 1
    s_cmp_eq_u32 s72, 7
    s_cselect_b32 s72, 0, s72
    s_lshl_b32 s8, s72, 13
    s_add_u32 s8, s8, s75
    s_add_u32 s72, s72, 1
    s_cmp_eq_u32 s72, 7
    s_cselect_b32 s72, 0, s72
    s_lshl_b32 s9, s72, 13
    s_add_u32 s9, s9, s75
    s_add_u32 s72, s72, 1
    s_cmp_eq_u32 s72, 7
    s_cselect_b32 s72, 0, s72
    s_lshl_b32 s10, s72, 13
    s_add_u32 s10, s10, s75
    v_mov_b32 v13, v4
    v_mov_b32 v68, v160
    v_mov_b32 v69, v161
    v_mov_b32 v70, v162
    v_mov_b32 v71, v163
    s_cmp_lg_u32 s70, 0
    s_cbranch_scc1 L_nf2p
    s_lshl_b32 s72, s68, 7
    s_add_u32 s72, s72, 0x6000
    v_min_u32 v10, 6, v1
    v_lshlrev_b32 v10, 2, v10
    s_mov_b32 s101, 0
poll_48:
    buffer_load_dword v11, v10, s[60:63], s72 offen sc1
    s_add_u32 s101, s101, 1
    s_cmp_gt_u32 s101, 0x61a80
    s_cbranch_scc1 polld_49
    s_waitcnt vmcnt(0)
    v_cmp_ne_u32 vcc, s71, v11
    s_cbranch_vccnz poll_48
polld_49:
    s_waitcnt vmcnt(0)
L_nf2p:
    s_nop 2
    s_waitcnt vmcnt(1)
    v_mov_b32 v18, 0x2720c
    v_mov_b32 v19, 1
    s_mov_b64 exec, 1
    ds_add_rtn_u32 v19, v18, v19
    s_mov_b64 exec, -1
    s_waitcnt lgkmcnt(0)
    v_readfirstlane_b32 s72, v19
    s_nop 0
    s_cmp_lg_u32 s72, 7
    s_cbranch_scc1 arr_50
    s_lshl_b32 s72, s68, 7
    s_lshl_b32 s73, s69, 2
    s_add_u32 s72, s72, s73
    s_add_u32 s72, s72, 0x7000
    v_mov_b32 v18, 0
    v_mov_b32 v19, s71
    s_mov_b64 exec, 1
    buffer_store_dword v19, v18, s[60:63], s72 offen sc1
    s_mov_b64 exec, -1
arr_50:
    s_add_u32 m0, s80, 0xc00
    s_add_u32 s79, s85, 0x1c00
    buffer_load_dwordx4 v8, s[44:47], s79 offen lds
    s_add_u32 s85, s85, 0x34800
    s_cmp_eq_u32 s88, 2
    s_cselect_b32 s79, 0x188000, 0
    s_sub_u32 s85, s85, s79
    s_add_u32 m0, s80, 0x1000
    s_nop 0
    buffer_load_dwordx4 v8, s[44:47], s85 offen lds
    s_add_u32 m0, s80, 0x1400
    s_add_u32 s79, s85, 0x1c00
    buffer_load_dwordx4 v8, s[44:47], s79 offen lds
    s_add_u32 s85, s85, 0x3800
    s_add_u32 m0, s80, 0x1800
    s_nop 0
    buffer_load_dwordx4 v8, s[44:47], s85 offen lds
    s_add_u32 m0, s80, 0x1c00
    s_add_u32 s79, s85, 0x1c00
    buffer_load_dwordx4 v8, s[44:47], s79 offen lds
    s_add_u32 s85, s85, 0x34800
    v_lshlrev_b32 v16, 5, v9
    v_add_u32 v16, s76, v16
    s_mov_b32 s72, 0x2300
    buffer_load_dwordx4 v[168:171], v16, s[60:63], s72 offen sc1
    buffer_load_dwordx4 v[172:175], v16, s[60:63], s72 offen offset:16 sc1
    s_barrier
    buffer_load_dwordx4 v[72:75], v13, s[60:63], s5 offen sc1
    buffer_load_dwordx4 v[76:79], v13, s[60:63], s6 offen sc1
    buffer_load_dwordx4 v[80:83], v13, s[60:63], s7 offen sc1
    buffer_load_dwordx4 v[84:87], v13, s[60:63], s8 offen sc1
    buffer_load_dwordx4 v[88:91], v13, s[60:63], s9 offen sc1
    buffer_load_dwordx4 v[92:95], v13, s[60:63], s10 offen sc1
    v_add_u32 v13, 0xe000, v13
    buffer_load_dwordx4 v[96:99], v13, s[60:63], s4 offen sc1
    buffer_load_dwordx4 v[100:103], v13, s[60:63], s5 offen sc1
    buffer_load_dwordx4 v[104:107], v13, s[60:63], s6 offen sc1
    buffer_load_dwordx4 v[108:111], v13, s[60:63], s7 offen sc1
    buffer_load_dwordx4 v[112:115], v13, s[60:63], s8 offen sc1
    buffer_load_dwordx4 v[116:119], v13, s[60:63], s9 offen sc1
    buffer_load_dwordx4 v[120:123], v13, s[60:63], s10 offen sc1
    v_add_u32 v13, 0xe000, v13
    ds_read_b64_tr_b16 v[36:37], v132 offset:0
    ds_read_b64_tr_b16 v[40:41], v133 offset:0
    ds_read_b64_tr_b16 v[44:45], v134 offset:0
    ds_read_b64_tr_b16 v[48:49], v135 offset:0
    s_waitcnt vmcnt(19)
    ds_read_b64_tr_b16 v[38:39], v132 offset:2048
    ds_read_b64_tr_b16 v[42:43], v133 offset:2048
    ds_read_b64_tr_b16 v[46:47], v134 offset:2048
    ds_read_b64_tr_b16 v[50:51], v135 offset:2048
    s_waitcnt vmcnt(17)
    ds_read_b64_tr_b16 v[52:53], v132 offset:4096
    ds_read_b64_tr_b16 v[56:57], v133 offset:4096
    ds_read_b64_tr_b16 v[60:61], v134 offset:4096
    ds_read_b64_tr_b16 v[64:65], v135 offset:4096
    s_waitcnt vmcnt(15)
    s_waitcnt lgkmcnt(11)
    ds_read_b64_tr_b16 v[54:55], v132 offset:6144
    ds_read_b64_tr_b16 v[58:59], v133 offset:6144
    ds_read_b64_tr_b16 v[62:63], v134 offset:6144
    ds_read_b64_tr_b16 v[66:67], v135 offset:6144
    s_waitcnt vmcnt(13)
    v_xor_b32 v18, s71, v169
    v_xor_b32 v19, s71, v171
    v_or_b32 v18, v18, v19
    v_xor_b32 v19, s71, v173
    v_or_b32 v18, v18, v19
    v_xor_b32 v19, s71, v175
    v_or_b32 v18, v18, v19
    v_cmp_ne_u32 vcc, 0, v18
    s_cbranch_vccz gok_51
    s_mov_b32 s101, 0
glp_52:
    s_mov_b32 s72, 0x2300
    buffer_load_dwordx4 v[168:171], v16, s[60:63], s72 offen sc1
    buffer_load_dwordx4 v[172:175], v16, s[60:63], s72 offen offset:16 sc1
    s_add_u32 s101, s101, 1
    s_cmp_gt_u32 s101, 0x61a80
    s_cbranch_scc1 gok_51
    s_waitcnt vmcnt(0)
    v_xor_b32 v18, s71, v169
    v_xor_b32 v19, s71, v171
    v_or_b32 v18, v18, v19
    v_xor_b32 v19, s71, v173
    v_or_b32 v18, v18, v19
    v_xor_b32 v19, s71, v175
    v_or_b32 v18, v18, v19
    v_cmp_ne_u32 vcc, 0, v18
    s_cbranch_vccnz glp_52
gok_51:
    s_nop 3
    v_lshlrev_b32 v124, 16, v168
    v_and_b32 v125, 0xffff0000, v168
    v_lshlrev_b32 v126, 16, v170
    v_and_b32 v127, 0xffff0000, v170
    v_lshlrev_b32 v128, 16, v172
    v_and_b32 v129, 0xffff0000, v172
    v_lshlrev_b32 v130, 16, v174
    v_and_b32 v131, 0xffff0000, v174
    s_cmp_lg_u32 s70, 0
    s_cbranch_scc1 L_nf3p
    s_lshl_b32 s72, s68, 7
    s_add_u32 s72, s72, 0x7000
    v_min_u32 v10, 6, v1
    v_lshlrev_b32 v10, 2, v10
    s_mov_b32 s101, 0
poll_53:
    buffer_load_dword v11, v10, s[60:63], s72 offen sc1
    s_add_u32 s101, s101, 1
    s_cmp_gt_u32 s101, 0x61a80
    s_cbranch_scc1 polld_54
    s_waitcnt vmcnt(0)
    v_cmp_ne_u32 vcc, s71, v11
    s_cbranch_vccnz poll_53
polld_54:
    s_waitcnt vmcnt(0)
L_nf3p:
    s_nop 2
    s_waitcnt lgkmcnt(0)
    s_barrier
    s_lshl_b32 s74, s70, 11
    v_add_u32 v14, s74, v4
    v_add_u32 v15, 0x10000, v14
    buffer_load_dwordx4 v[140:143], v13, s[60:63], s5 offen sc1
    buffer_load_dwordx4 v[148:151], v13, s[60:63], s6 offen sc1
    buffer_load_dwordx4 v[152:155], v13, s[60:63], s7 offen sc1
    buffer_load_dwordx4 v[156:159], v13, s[60:63], s8 offen sc1
    buffer_load_dwordx4 v[160:163], v13, s[60:63], s9 offen sc1
    buffer_load_dwordx4 v[164:167], v13, s[60:63], s10 offen sc1
    v_add_u32 v13, 0xe000, v13
    v_mfma_f32_16x16x32_bf16 v[168:171], v[192:195], v[188:191], 0
    v_mfma_f32_16x16x32_bf16 v[172:175], v[196:199], v[188:191], 0
    v_mfma_f32_16x16x32_bf16 v[176:179], v[200:203], v[188:191], 0
    v_mfma_f32_16x16x32_bf16 v[180:183], v[204:207], v[188:191], 0
    s_waitcnt vmcnt(18)
    v_mfma_f32_16x16x32_bf16 v[168:171], v[208:211], v[72:75], v[168:171]
    v_mfma_f32_16x16x32_bf16 v[172:175], v[212:215], v[72:75], v[172:175]
    v_mfma_f32_16x16x32_bf16 v[176:179], v[216:219], v[72:75], v[176:179]
    v_mfma_f32_16x16x32_bf16 v[180:183], v[220:223], v[72:75], v[180:183]
    s_waitcnt vmcnt(17)
    v_mfma_f32_16x16x32_bf16 v[168:171], v[224:227], v[76:79], v[168:171]
    v_mfma_f32_16x16x32_bf16 v[172:175], v[228:231], v[76:79], v[172:175]
    v_mfma_f32_16x16x32_bf16 v[176:179], v[232:235], v[76:79], v[176:179]
    v_mfma_f32_16x16x32_bf16 v[180:183], v[236:239], v[76:79], v[180:183]
    s_waitcnt vmcnt(16)
    v_mfma_f32_16x16x32_bf16 v[168:171], v[240:243], v[80:83], v[168:171]
    v_mfma_f32_16x16x32_bf16 v[172:175], v[244:247], v[80:83], v[172:175]
    v_mfma_f32_16x16x32_bf16 v[176:179], v[248:251], v[80:83], v[176:179]
    v_mfma_f32_16x16x32_bf16 v[180:183], v[252:255], v[80:83], v[180:183]
    s_waitcnt vmcnt(15)
    v_mfma_f32_16x16x32_bf16 v[168:171], v[20:23], v[84:87], v[168:171]
    v_mfma_f32_16x16x32_bf16 v[172:175], v[24:27], v[84:87], v[172:175]
    v_mfma_f32_16x16x32_bf16 v[176:179], v[28:31], v[84:87], v[176:179]
    v_mfma_f32_16x16x32_bf16 v[180:183], v[32:35], v[84:87], v[180:183]
    s_waitcnt vmcnt(14)
    v_mfma_f32_16x16x32_bf16 v[168:171], v[36:39], v[88:91], v[168:171]
    v_mfma_f32_16x16x32_bf16 v[172:175], v[40:43], v[88:91], v[172:175]
    v_mfma_f32_16x16x32_bf16 v[176:179], v[44:47], v[88:91], v[176:179]
    v_mfma_f32_16x16x32_bf16 v[180:183], v[48:51], v[88:91], v[180:183]
    s_waitcnt vmcnt(13)
    v_mfma_f32_16x16x32_bf16 v[168:171], v[52:55], v[92:95], v[168:171]
    v_mfma_f32_16x16x32_bf16 v[172:175], v[56:59], v[92:95], v[172:175]
    v_mfma_f32_16x16x32_bf16 v[176:179], v[60:63], v[92:95], v[176:179]
    v_mfma_f32_16x16x32_bf16 v[180:183], v[64:67], v[92:95], v[180:183]
    buffer_load_dwordx4 v[72:75], v13, s[60:63], s5 offen sc1
    buffer_load_dwordx4 v[76:79], v13, s[60:63], s6 offen sc1
    buffer_load_dwordx4 v[80:83], v13, s[60:63], s7 offen sc1
    buffer_load_dwordx4 v[84:87], v13, s[60:63], s8 offen sc1
    buffer_load_dwordx4 v[88:91], v13, s[60:63], s9 offen sc1
    buffer_load_dwordx4 v[92:95], v13, s[60:63], s10 offen sc1
    v_add_u32 v13, 0xe000, v13
    s_waitcnt vmcnt(18)
    v_mfma_f32_16x16x32_bf16 v[132:135], v[192:195], v[96:99], 0
    v_mfma_f32_16x16x32_bf16 v[136:139], v[196:199], v[96:99], 0
    v_mfma_f32_16x16x32_bf16 v[188:191], v[200:203], v[96:99], 0
    v_mfma_f32_16x16x32_bf16 v[16:19], v[204:207], v[96:99], 0
    s_waitcnt vmcnt(17)
    v_mfma_f32_16x16x32_bf16 v[132:135], v[208:211], v[100:103], v[132:135]
    v_mfma_f32_16x16x32_bf16 v[136:139], v[212:215], v[100:103], v[136:139]
    v_mfma_f32_16x16x32_bf16 v[188:191], v[216:219], v[100:103], v[188:191]
    v_mfma_f32_16x16x32_bf16 v[16:19], v[220:223], v[100:103], v[16:19]
    ds_write_b128 v14, v[168:171] offset:0
    ds_write_b128 v14, v[172:175] offset:1024
    ds_write_b128 v14, v[176:179] offset:16384
    ds_write_b128 v14, v[180:183] offset:17408
    s_waitcnt vmcnt(16)
    v_mfma_f32_16x16x32_bf16 v[132:135], v[224:227], v[104:107], v[132:135]
    v_mfma_f32_16x16x32_bf16 v[136:139], v[228:231], v[104:107], v[136:139]
    v_mfma_f32_16x16x32_bf16 v[188:191], v[232:235], v[104:107], v[188:191]
    v_mfma_f32_16x16x32_bf16 v[16:19], v[236:239], v[104:107], v[16:19]
    s_waitcnt vmcnt(15)
    v_mfma_f32_16x16x32_bf16 v[132:135], v[240:243], v[108:111], v[132:135]
    v_mfma_f32_16x16x32_bf16 v[136:139], v[244:247], v[108:111], v[136:139]
    v_mfma_f32_16x16x32_bf16 v[188:191], v[248:251], v[108:111], v[188:191]
    v_mfma_f32_16x16x32_bf16 v[16:19], v[252:255], v[108:111], v[16:19]
    s_waitcnt vmcnt(14)
    v_mfma_f32_16x16x32_bf16 v[132:135], v[20:23], v[112:115], v[132:135]
    v_mfma_f32_16x16x32_bf16 v[136:139], v[24:27], v[112:115], v[136:139]
    v_mfma_f32_16x16x32_bf16 v[188:191], v[28:31], v[112:115], v[188:191]
    v_mfma_f32_16x16x32_bf16 v[16:19], v[32:35], v[112:115], v[16:19]
    s_waitcnt vmcnt(13)
    v_mfma_f32_16x16x32_bf16 v[132:135], v[36:39], v[116:119], v[132:135]
    v_mfma_f32_16x16x32_bf16 v[136:139], v[40:43], v[116:119], v[136:139]
    v_mfma_f32_16x16x32_bf16 v[188:191], v[44:47], v[116:119], v[188:191]
    v_mfma_f32_16x16x32_bf16 v[16:19], v[48:51], v[116:119], v[16:19]
    s_waitcnt vmcnt(12)
    v_mfma_f32_16x16x32_bf16 v[132:135], v[52:55], v[120:123], v[132:135]
    v_mfma_f32_16x16x32_bf16 v[136:139], v[56:59], v[120:123], v[136:139]
    v_mfma_f32_16x16x32_bf16 v[188:191], v[60:63], v[120:123], v[188:191]
    v_mfma_f32_16x16x32_bf16 v[16:19], v[64:67], v[120:123], v[16:19]
    s_waitcnt lgkmcnt(0)
    v_mfma_f32_16x16x32_bf16 v[168:171], v[192:195], v[144:147], 0
    v_mfma_f32_16x16x32_bf16 v[172:175], v[196:199], v[144:147], 0
    v_mfma_f32_16x16x32_bf16 v[176:179], v[200:203], v[144:147], 0
    v_mfma_f32_16x16x32_bf16 v[180:183], v[204:207], v[144:147], 0
    s_waitcnt vmcnt(11)
    v_mfma_f32_16x16x32_bf16 v[168:171], v[208:211], v[140:143], v[168:171]
    v_mfma_f32_16x16x32_bf16 v[172:175], v[212:215], v[140:143], v[172:175]
    v_mfma_f32_16x16x32_bf16 v[176:179], v[216:219], v[140:143], v[176:179]
    v_mfma_f32_16x16x32_bf16 v[180:183], v[220:223], v[140:143], v[180:183]
    ds_write_b128 v14, v[132:135] offset:32768
    ds_write_b128 v14, v[136:139] offset:33792
    ds_write_b128 v14, v[188:191] offset:49152
    ds_write_b128 v14, v[16:19] offset:50176
    s_waitcnt vmcnt(10)
    v_mfma_f32_16x16x32_bf16 v[168:171], v[224:227], v[148:151], v[168:171]
    v_mfma_f32_16x16x32_bf16 v[172:175], v[228:231], v[148:151], v[172:175]
    v_mfma_f32_16x16x32_bf16 v[176:179], v[232:235], v[148:151], v[176:179]
    v_mfma_f32_16x16x32_bf16 v[180:183], v[236:239], v[148:151], v[180:183]
    s_waitcnt vmcnt(9)
    v_mfma_f32_16x16x32_bf16 v[168:171], v[240:243], v[152:155], v[168:171]
    v_mfma_f32_16x16x32_bf16 v[172:175], v[244:247], v[152:155], v[172:175]
    v_mfma_f32_16x16x32_bf16 v[176:179], v[248:251], v[152:155], v[176:179]
    v_mfma_f32_16x16x32_bf16 v[180:183], v[252:255], v[152:155], v[180:183]
    s_waitcnt vmcnt(8)
    v_mfma_f32_16x16x32_bf16 v[168:171], v[20:23], v[156:159], v[168:171]
    v_mfma_f32_16x16x32_bf16 v[172:175], v[24:27], v[156:159], v[172:175]
    v_mfma_f32_16x16x32_bf16 v[176:179], v[28:31], v[156:159], v[176:179]
    v_mfma_f32_16x16x32_bf16 v[180:183], v[32:35], v[156:159], v[180:183]
    s_waitcnt vmcnt(7)
    v_mfma_f32_16x16x32_bf16 v[168:171], v[36:39], v[160:163], v[168:171]
    v_mfma_f32_16x16x32_bf16 v[172:175], v[40:43], v[160:163], v[172:175]
    v_mfma_f32_16x16x32_bf16 v[176:179], v[44:47], v[160:163], v[176:179]
    v_mfma_f32_16x16x32_bf16 v[180:183], v[48:51], v[160:163], v[180:183]
    s_waitcnt vmcnt(6)
    v_mfma_f32_16x16x32_bf16 v[168:171], v[52:55], v[164:167], v[168:171]
    v_mfma_f32_16x16x32_bf16 v[172:175], v[56:59], v[164:167], v[172:175]
    v_mfma_f32_16x16x32_bf16 v[176:179], v[60:63], v[164:167], v[176:179]
    v_mfma_f32_16x16x32_bf16 v[180:183], v[64:67], v[164:167], v[180:183]
    s_waitcnt lgkmcnt(0)
    v_mfma_f32_16x16x32_bf16 v[132:135], v[192:195], v[68:71], 0
    v_mfma_f32_16x16x32_bf16 v[136:139], v[196:199], v[68:71], 0
    v_mfma_f32_16x16x32_bf16 v[188:191], v[200:203], v[68:71], 0
    v_mfma_f32_16x16x32_bf16 v[16:19], v[204:207], v[68:71], 0
    s_waitcnt vmcnt(5)
    v_mfma_f32_16x16x32_bf16 v[132:135], v[208:211], v[72:75], v[132:135]
    v_mfma_f32_16x16x32_bf16 v[136:139], v[212:215], v[72:75], v[136:139]
    v_mfma_f32_16x16x32_bf16 v[188:191], v[216:219], v[72:75], v[188:191]
    v_mfma_f32_16x16x32_bf16 v[16:19], v[220:223], v[72:75], v[16:19]
    ds_write_b128 v15, v[168:171] offset:0
    ds_write_b128 v15, v[172:175] offset:1024
    ds_write_b128 v15, v[176:179] offset:16384
    ds_write_b128 v15, v[180:183] offset:17408
    s_waitcnt vmcnt(4)
    v_mfma_f32_16x16x32_bf16 v[132:135], v[224:227], v[76:79], v[132:135]
    v_mfma_f32_16x16x32_bf16 v[136:139], v[228:231], v[76:79], v[136:139]
    v_mfma_f32_16x16x32_bf16 v[188:191], v[232:235], v[76:79], v[188:191]
    v_mfma_f32_16x16x32_bf16 v[16:19], v[236:239], v[76:79], v[16:19]
    s_waitcnt vmcnt(3)
    v_mfma_f32_16x16x32_bf16 v[132:135], v[240:243], v[80:83], v[132:135]
    v_mfma_f32_16x16x32_bf16 v[136:139], v[244:247], v[80:83], v[136:139]
    v_mfma_f32_16x16x32_bf16 v[188:191], v[248:251], v[80:83], v[188:191]
    v_mfma_f32_16x16x32_bf16 v[16:19], v[252:255], v[80:83], v[16:19]
    s_waitcnt vmcnt(2)
    v_mfma_f32_16x16x32_bf16 v[132:135], v[20:23], v[84:87], v[132:135]
    v_mfma_f32_16x16x32_bf16 v[136:139], v[24:27], v[84:87], v[136:139]
    v_mfma_f32_16x16x32_bf16 v[188:191], v[28:31], v[84:87], v[188:191]
    v_mfma_f32_16x16x32_bf16 v[16:19], v[32:35], v[84:87], v[16:19]
    s_waitcnt vmcnt(1)
    v_mfma_f32_16x16x32_bf16 v[132:135], v[36:39], v[88:91], v[132:135]
    v_mfma_f32_16x16x32_bf16 v[136:139], v[40:43], v[88:91], v[136:139]
    v_mfma_f32_16x16x32_bf16 v[188:191], v[44:47], v[88:91], v[188:191]
    v_mfma_f32_16x16x32_bf16 v[16:19], v[48:51], v[88:91], v[16:19]
    s_waitcnt vmcnt(0)
    v_mfma_f32_16x16x32_bf16 v[132:135], v[52:55], v[92:95], v[132:135]
    v_mfma_f32_16x16x32_bf16 v[136:139], v[56:59], v[92:95], v[136:139]
    v_mfma_f32_16x16x32_bf16 v[188:191], v[60:63], v[92:95], v[188:191]
    v_mfma_f32_16x16x32_bf16 v[16:19], v[64:67], v[92:95], v[16:19]
    s_nop 4
    ds_write_b128 v15, v[132:135] offset:32768
    ds_write_b128 v15, v[136:139] offset:33792
    ds_write_b128 v15, v[188:191] offset:49152
    ds_write_b128 v15, v[16:19] offset:50176
    s_waitcnt lgkmcnt(0)
    s_barrier
    s_lshl_b32 s73, s70, 14
    v_add_u32 v10, s73, v4
    ds_read_b128 v[20:23], v10 offset:0
    ds_read_b128 v[24:27], v10 offset:1024
    ds_read_b128 v[28:31], v10 offset:2048
    ds_read_b128 v[32:35], v10 offset:3072
    ds_read_b128 v[36:39], v10 offset:4096
    ds_read_b128 v[40:43], v10 offset:5120
    ds_read_b128 v[44:47], v10 offset:6144
    ds_read_b128 v[48:51], v10 offset:7168
    ds_read_b128 v[52:55], v10 offset:8192
    ds_read_b128 v[56:59], v10 offset:9216
    ds_read_b128 v[60:63], v10 offset:10240
    ds_read_b128 v[64:67], v10 offset:11264
    ds_read_b128 v[68:71], v10 offset:12288
    ds_read_b128 v[72:75], v10 offset:13312
    s_waitcnt lgkmcnt(13)
    ds_read_b128 v[76:79], v10 offset:14336
    ds_read_b128 v[80:83], v10 offset:15360
    s_waitcnt lgkmcnt(0)
    v_pk_add_f32 v[20:21], v[20:21], v[28:29]
    v_pk_add_f32 v[22:23], v[22:23], v[30:31]
    v_pk_add_f32 v[24:25], v[24:25], v[32:33]
    v_pk_add_f32 v[26:27], v[26:27], v[34:35]
    v_pk_add_f32 v[20:21], v[20:21], v[36:37]
    v_pk_add_f32 v[22:23], v[22:23], v[38:39]
    v_pk_add_f32 v[24:25], v[24:25], v[40:41]
    v_pk_add_f32 v[26:27], v[26:27], v[42:43]
    v_pk_add_f32 v[20:21], v[20:21], v[44:45]
    v_pk_add_f32 v[22:23], v[22:23], v[46:47]
    v_pk_add_f32 v[24:25], v[24:25], v[48:49]
    v_pk_add_f32 v[26:27], v[26:27], v[50:51]
    v_pk_add_f32 v[52:53], v[52:53], v[60:61]
    v_pk_add_f32 v[54:55], v[54:55], v[62:63]
    v_pk_add_f32 v[56:57], v[56:57], v[64:65]
    v_pk_add_f32 v[58:59], v[58:59], v[66:67]
    v_pk_add_f32 v[52:53], v[52:53], v[68:69]
    v_pk_add_f32 v[54:55], v[54:55], v[70:71]
    v_pk_add_f32 v[56:57], v[56:57], v[72:73]
    v_pk_add_f32 v[58:59], v[58:59], v[74:75]
    v_pk_add_f32 v[52:53], v[52:53], v[76:77]
    v_pk_add_f32 v[54:55], v[54:55], v[78:79]
    v_pk_add_f32 v[56:57], v[56:57], v[80:81]
    v_pk_add_f32 v[58:59], v[58:59], v[82:83]
    v_pk_add_f32 v[20:21], v[20:21], v[52:53]
    v_pk_add_f32 v[22:23], v[22:23], v[54:55]
    v_pk_add_f32 v[24:25], v[24:25], v[56:57]
    v_pk_add_f32 v[26:27], v[26:27], v[58:59]
    s_nop 0
    v_permlane16_swap_b32 v20, v24
    v_permlane16_swap_b32 v21, v25
    v_permlane16_swap_b32 v22, v26
    v_permlane16_swap_b32 v23, v27
    v_lshlrev_b32 v112, 16, v184
    v_and_b32 v113, 0xffff0000, v184
    v_lshlrev_b32 v114, 16, v185
    v_and_b32 v115, 0xffff0000, v185
    v_lshlrev_b32 v116, 16, v186
    v_and_b32 v117, 0xffff0000, v186
    v_lshlrev_b32 v118, 16, v187
    v_and_b32 v119, 0xffff0000, v187
    v_pk_fma_f32 v[104:105], v[20:21], v[124:125], v[112:113]
    v_pk_fma_f32 v[106:107], v[22:23], v[126:127], v[114:115]
    v_pk_fma_f32 v[108:109], v[24:25], v[128:129], v[116:117]
    v_pk_fma_f32 v[110:111], v[26:27], v[130:131], v[118:119]
    v_cvt_pk_bf16_f32 v100, v104, v105
    v_cvt_pk_bf16_f32 v101, v106, v107
    v_cvt_pk_bf16_f32 v102, v108, v109
    v_cvt_pk_bf16_f32 v103, v110, v111
    buffer_store_dwordx4 v[100:103], v7, s[56:59], s77 offen
    s_branch L_exit7
L_service:
    s_nop 2
    v_and_b32 v10, 56, v1
    s_lshl_b32 s72, s70, 7
    v_lshlrev_b32 v11, 1, v10
    buffer_load_dwordx4 v[252:255], v11, s[48:51], s72 offen
    v_and_b32 v10, 56, v1
    s_lshl_b32 s72, s70, 6
    v_add_u32 v10, s72, v10
    v_mul_u32_u24 v10, 0x1500, v10
    v_and_b32 v12, 7, v1
    v_lshl_add_u32 v10, v12, 4, v10
    s_lshl_b32 s72, s68, 7
    s_add_u32 s72, s72, 0xa80
    buffer_load_dwordx4 v[216:219], v10, s[52:55], s72 offen
    s_add_u32 s72, s72, 0x1500
    buffer_load_dwordx4 v[220:223], v10, s[52:55], s72 offen
    s_add_u32 s72, s72, 0x1500
    buffer_load_dwordx4 v[224:227], v10, s[52:55], s72 offen
    s_add_u32 s72, s72, 0x1500
    buffer_load_dwordx4 v[228:231], v10, s[52:55], s72 offen
    s_add_u32 s72, s72, 0x1500
    buffer_load_dwordx4 v[232:235], v10, s[52:55], s72 offen
    s_add_u32 s72, s72, 0x1500
    buffer_load_dwordx4 v[236:239], v10, s[52:55], s72 offen
    s_add_u32 s72, s72, 0x1500
    buffer_load_dwordx4 v[240:243], v10, s[52:55], s72 offen
    s_add_u32 s72, s72, 0x1500
    buffer_load_dwordx4 v[244:247], v10, s[52:55], s72 offen
    s_waitcnt vmcnt(9)
    v_mov_b32 v18, 0x27200
    v_mov_b32 v19, 1
    s_mov_b64 exec, 1
    ds_add_rtn_u32 v19, v18, v19
    s_mov_b64 exec, -1
    s_waitcnt lgkmcnt(0)
    v_readfirstlane_b32 s72, v19
    s_nop 0
    s_cmp_lg_u32 s72, 7
    s_cbranch_scc1 arr_55
    s_lshl_b32 s72, s68, 7
    s_lshl_b32 s73, s69, 2
    s_add_u32 s72, s72, s73
    s_add_u32 s72, s72, 0x4000
    v_mov_b32 v18, 0
    v_mov_b32 v19, s71
    s_mov_b64 exec, 1
    buffer_store_dword v19, v18, s[60:63], s72 offen sc1
    s_mov_b64 exec, -1
arr_55:
    s_cmp_eq_u32 s78, -1
    s_cbranch_scc1 L_exit7
    s_waitcnt vmcnt(0)
    v_lshlrev_b32 v248, 16, v252
    v_and_b32 v249, 0xffff0000, v252
    v_lshlrev_b32 v250, 16, v253
    v_and_b32 v251, 0xffff0000, v253
    v_mov_b32 v18, v254
    v_mov_b32 v19, v255
    v_lshlrev_b32 v252, 16, v18
    v_and_b32 v253, 0xffff0000, v18
    v_lshlrev_b32 v254, 16, v19
    v_and_b32 v255, 0xffff0000, v19
    v_mul_f32 v10, 0xbfb8aa3b, v248
    v_mul_f32 v11, 0xbfb8aa3b, v249
    v_mul_f32 v12, 0xbfb8aa3b, v250
    v_mul_f32 v13, 0xbfb8aa3b, v251
    v_mul_f32 v14, 0xbfb8aa3b, v252
    v_mul_f32 v15, 0xbfb8aa3b, v253
    v_mul_f32 v16, 0xbfb8aa3b, v254
    v_mul_f32 v17, 0xbfb8aa3b, v255
    v_exp_f32 v10, v10
    v_exp_f32 v11, v11
    v_exp_f32 v12, v12
    v_exp_f32 v13, v13
    v_exp_f32 v14, v14
    v_exp_f32 v15, v15
    v_exp_f32 v16, v16
    v_exp_f32 v17, v17
    v_add_f32 v10, 1.0, v10
    v_add_f32 v11, 1.0, v11
    v_add_f32 v12, 1.0, v12
    v_add_f32 v13, 1.0, v13
    v_add_f32 v14, 1.0, v14
    v_add_f32 v15, 1.0, v15
    v_add_f32 v16, 1.0, v16
    v_add_f32 v17, 1.0, v17
    v_rcp_f32 v10, v10
    v_rcp_f32 v11, v11
    v_rcp_f32 v12, v12
    v_rcp_f32 v13, v13
    v_rcp_f32 v14, v14
    v_rcp_f32 v15, v15
    v_rcp_f32 v16, v16
    v_rcp_f32 v17, v17
    v_mul_f32 v248, v248, v10
    v_mul_f32 v249, v249, v11
    v_mul_f32 v250, v250, v12
    v_mul_f32 v251, v251, v13
    v_mul_f32 v252, v252, v14
    v_mul_f32 v253, v253, v15
    v_mul_f32 v254, v254, v16
    v_mul_f32 v255, v255, v17
    v_cvt_pk_bf16_f32 v10, v248, v249
    v_lshlrev_b32 v248, 16, v10
    v_and_b32 v249, 0xffff0000, v10
    v_cvt_pk_bf16_f32 v11, v250, v251
    v_lshlrev_b32 v250, 16, v11
    v_and_b32 v251, 0xffff0000, v11
    v_cvt_pk_bf16_f32 v12, v252, v253
    v_lshlrev_b32 v252, 16, v12
    v_and_b32 v253, 0xffff0000, v12
    v_cvt_pk_bf16_f32 v13, v254, v255
    v_lshlrev_b32 v254, 16, v13
    v_and_b32 v255, 0xffff0000, v13
    v_lshlrev_b32 v144, 16, v216
    v_and_b32 v145, 0xffff0000, v216
    v_pk_mul_f32 v[136:137], v[144:145], v[248:249] op_sel:[0,0] op_sel_hi:[1,0]
    v_lshlrev_b32 v146, 16, v217
    v_and_b32 v147, 0xffff0000, v217
    v_pk_mul_f32 v[138:139], v[146:147], v[248:249] op_sel:[0,0] op_sel_hi:[1,0]
    v_lshlrev_b32 v144, 16, v218
    v_and_b32 v145, 0xffff0000, v218
    v_pk_mul_f32 v[140:141], v[144:145], v[248:249] op_sel:[0,0] op_sel_hi:[1,0]
    v_lshlrev_b32 v146, 16, v219
    v_and_b32 v147, 0xffff0000, v219
    v_pk_mul_f32 v[142:143], v[146:147], v[248:249] op_sel:[0,0] op_sel_hi:[1,0]
    v_lshlrev_b32 v144, 16, v220
    v_and_b32 v145, 0xffff0000, v220
    v_pk_fma_f32 v[136:137], v[144:145], v[248:249], v[136:137] op_sel:[0,1,0] op_sel_hi:[1,1,1]
    v_lshlrev_b32 v146, 16, v221
    v_and_b32 v147, 0xffff0000, v221
    v_pk_fma_f32 v[138:139], v[146:147], v[248:249], v[138:139] op_sel:[0,1,0] op_sel_hi:[1,1,1]
    v_lshlrev_b32 v144, 16, v222
    v_and_b32 v145, 0xffff0000, v222
    v_pk_fma_f32 v[140:141], v[144:145], v[248:249], v[140:141] op_sel:[0,1,0] op_sel_hi:[1,1,1]
    v_lshlrev_b32 v146, 16, v223
    v_and_b32 v147, 0xffff0000, v223
    v_pk_fma_f32 v[142:143], v[146:147], v[248:249], v[142:143] op_sel:[0,1,0] op_sel_hi:[1,1,1]
    v_lshlrev_b32 v144, 16, v224
    v_and_b32 v145, 0xffff0000, v224
    v_pk_fma_f32 v[136:137], v[144:145], v[250:251], v[136:137] op_sel:[0,0,0] op_sel_hi:[1,0,1]
    v_lshlrev_b32 v146, 16, v225
    v_and_b32 v147, 0xffff0000, v225
    v_pk_fma_f32 v[138:139], v[146:147], v[250:251], v[138:139] op_sel:[0,0,0] op_sel_hi:[1,0,1]
    v_lshlrev_b32 v144, 16, v226
    v_and_b32 v145, 0xffff0000, v226
    v_pk_fma_f32 v[140:141], v[144:145], v[250:251], v[140:141] op_sel:[0,0,0] op_sel_hi:[1,0,1]
    v_lshlrev_b32 v146, 16, v227
    v_and_b32 v147, 0xffff0000, v227
    v_pk_fma_f32 v[142:143], v[146:147], v[250:251], v[142:143] op_sel:[0,0,0] op_sel_hi:[1,0,1]
    v_lshlrev_b32 v144, 16, v228
    v_and_b32 v145, 0xffff0000, v228
    v_pk_fma_f32 v[136:137], v[144:145], v[250:251], v[136:137] op_sel:[0,1,0] op_sel_hi:[1,1,1]
    v_lshlrev_b32 v146, 16, v229
    v_and_b32 v147, 0xffff0000, v229
    v_pk_fma_f32 v[138:139], v[146:147], v[250:251], v[138:139] op_sel:[0,1,0] op_sel_hi:[1,1,1]
    v_lshlrev_b32 v144, 16, v230
    v_and_b32 v145, 0xffff0000, v230
    v_pk_fma_f32 v[140:141], v[144:145], v[250:251], v[140:141] op_sel:[0,1,0] op_sel_hi:[1,1,1]
    v_lshlrev_b32 v146, 16, v231
    v_and_b32 v147, 0xffff0000, v231
    v_pk_fma_f32 v[142:143], v[146:147], v[250:251], v[142:143] op_sel:[0,1,0] op_sel_hi:[1,1,1]
    v_lshlrev_b32 v144, 16, v232
    v_and_b32 v145, 0xffff0000, v232
    v_pk_fma_f32 v[136:137], v[144:145], v[252:253], v[136:137] op_sel:[0,0,0] op_sel_hi:[1,0,1]
    v_lshlrev_b32 v146, 16, v233
    v_and_b32 v147, 0xffff0000, v233
    v_pk_fma_f32 v[138:139], v[146:147], v[252:253], v[138:139] op_sel:[0,0,0] op_sel_hi:[1,0,1]
    v_lshlrev_b32 v144, 16, v234
    v_and_b32 v145, 0xffff0000, v234
    v_pk_fma_f32 v[140:141], v[144:145], v[252:253], v[140:141] op_sel:[0,0,0] op_sel_hi:[1,0,1]
    v_lshlrev_b32 v146, 16, v235
    v_and_b32 v147, 0xffff0000, v235
    v_pk_fma_f32 v[142:143], v[146:147], v[252:253], v[142:143] op_sel:[0,0,0] op_sel_hi:[1,0,1]
    v_lshlrev_b32 v144, 16, v236
    v_and_b32 v145, 0xffff0000, v236
    v_pk_fma_f32 v[136:137], v[144:145], v[252:253], v[136:137] op_sel:[0,1,0] op_sel_hi:[1,1,1]
    v_lshlrev_b32 v146, 16, v237
    v_and_b32 v147, 0xffff0000, v237
    v_pk_fma_f32 v[138:139], v[146:147], v[252:253], v[138:139] op_sel:[0,1,0] op_sel_hi:[1,1,1]
    v_lshlrev_b32 v144, 16, v238
    v_and_b32 v145, 0xffff0000, v238
    v_pk_fma_f32 v[140:141], v[144:145], v[252:253], v[140:141] op_sel:[0,1,0] op_sel_hi:[1,1,1]
    v_lshlrev_b32 v146, 16, v239
    v_and_b32 v147, 0xffff0000, v239
    v_pk_fma_f32 v[142:143], v[146:147], v[252:253], v[142:143] op_sel:[0,1,0] op_sel_hi:[1,1,1]
    v_lshlrev_b32 v144, 16, v240
    v_and_b32 v145, 0xffff0000, v240
    v_pk_fma_f32 v[136:137], v[144:145], v[254:255], v[136:137] op_sel:[0,0,0] op_sel_hi:[1,0,1]
    v_lshlrev_b32 v146, 16, v241
    v_and_b32 v147, 0xffff0000, v241
    v_pk_fma_f32 v[138:139], v[146:147], v[254:255], v[138:139] op_sel:[0,0,0] op_sel_hi:[1,0,1]
    v_lshlrev_b32 v144, 16, v242
    v_and_b32 v145, 0xffff0000, v242
    v_pk_fma_f32 v[140:141], v[144:145], v[254:255], v[140:141] op_sel:[0,0,0] op_sel_hi:[1,0,1]
    v_lshlrev_b32 v146, 16, v243
    v_and_b32 v147, 0xffff0000, v243
    v_pk_fma_f32 v[142:143], v[146:147], v[254:255], v[142:143] op_sel:[0,0,0] op_sel_hi:[1,0,1]
    v_lshlrev_b32 v144, 16, v244
    v_and_b32 v145, 0xffff0000, v244
    v_pk_fma_f32 v[136:137], v[144:145], v[254:255], v[136:137] op_sel:[0,1,0] op_sel_hi:[1,1,1]
    v_lshlrev_b32 v146, 16, v245
    v_and_b32 v147, 0xffff0000, v245
    v_pk_fma_f32 v[138:139], v[146:147], v[254:255], v[138:139] op_sel:[0,1,0] op_sel_hi:[1,1,1]
    v_lshlrev_b32 v144, 16, v246
    v_and_b32 v145, 0xffff0000, v246
    v_pk_fma_f32 v[140:141], v[144:145], v[254:255], v[140:141] op_sel:[0,1,0] op_sel_hi:[1,1,1]
    v_lshlrev_b32 v146, 16, v247
    v_and_b32 v147, 0xffff0000, v247
    v_pk_fma_f32 v[142:143], v[146:147], v[254:255], v[142:143] op_sel:[0,1,0] op_sel_hi:[1,1,1]
    v_add_f32_dpp v136, v136, v136 row_ror:8 row_mask:0xf bank_mask:0xf
    v_add_f32_dpp v137, v137, v137 row_ror:8 row_mask:0xf bank_mask:0xf
    v_add_f32_dpp v138, v138, v138 row_ror:8 row_mask:0xf bank_mask:0xf
    v_add_f32_dpp v139, v139, v139 row_ror:8 row_mask:0xf bank_mask:0xf
    v_add_f32_dpp v140, v140, v140 row_ror:8 row_mask:0xf bank_mask:0xf
    v_add_f32_dpp v141, v141, v141 row_ror:8 row_mask:0xf bank_mask:0xf
    v_add_f32_dpp v142, v142, v142 row_ror:8 row_mask:0xf bank_mask:0xf
    v_add_f32_dpp v143, v143, v143 row_ror:8 row_mask:0xf bank_mask:0xf
    s_lshl_b32 s72, s70, 10
    s_add_u32 s72, s72, 0x24800
    v_lshlrev_b32 v10, 8, v3
    v_lshl_add_u32 v10, v2, 5, v10
    v_add_u32 v10, s72, v10
    v_cmp_gt_u32 vcc, 8, v2
    s_nop 0
    s_and_saveexec_b64 s[26:27], vcc
    ds_write_b128 v10, v[136:139]
    ds_write_b128 v10, v[140:143] offset:16
    s_mov_b64 exec, -1
    s_waitcnt lgkmcnt(0)
    s_barrier
    s_cmp_lg_u32 s70, 0
    s_cbranch_scc1 L_exit7
    v_lshrrev_b32 v10, 5, v1
    v_mul_u32_u24 v10, 0xe00, v10
    v_and_b32 v11, 31, v1
    v_lshl_add_u32 v10, v11, 3, v10
    v_add_u32 v10, 0x24800, v10
    ds_read_b64 v[136:137], v10 offset:0
    ds_read_b64 v[138:139], v10 offset:256
    ds_read_b64 v[140:141], v10 offset:512
    ds_read_b64 v[142:143], v10 offset:768
    ds_read_b64 v[144:145], v10 offset:1024
    ds_read_b64 v[146:147], v10 offset:1280
    ds_read_b64 v[148:149], v10 offset:1536
    ds_read_b64 v[150:151], v10 offset:1792
    ds_read_b64 v[152:153], v10 offset:2048
    ds_read_b64 v[154:155], v10 offset:2304
    ds_read_b64 v[156:157], v10 offset:2560
    ds_read_b64 v[158:159], v10 offset:2816
    ds_read_b64 v[160:161], v10 offset:3072
    ds_read_b64 v[162:163], v10 offset:3328
    s_waitcnt lgkmcnt(0)
    v_pk_add_f32 v[136:137], v[136:137], v[138:139]
    v_pk_add_f32 v[150:151], v[150:151], v[152:153]
    v_pk_add_f32 v[136:137], v[136:137], v[140:141]
    v_pk_add_f32 v[150:151], v[150:151], v[154:155]
    v_pk_add_f32 v[136:137], v[136:137], v[142:143]
    v_pk_add_f32 v[150:151], v[150:151], v[156:157]
    v_pk_add_f32 v[136:137], v[136:137], v[144:145]
    v_pk_add_f32 v[150:151], v[150:151], v[158:159]
    v_pk_add_f32 v[136:137], v[136:137], v[146:147]
    v_pk_add_f32 v[150:151], v[150:151], v[160:161]
    v_pk_add_f32 v[136:137], v[136:137], v[148:149]
    v_pk_add_f32 v[150:151], v[150:151], v[162:163]
    v_pk_add_f32 v[136:137], v[136:137], v[150:151]
    v_mov_b32 v12, v136
    v_mov_b32 v13, v137
    s_nop 0
    v_permlane32_swap_b32 v136, v12
    v_permlane32_swap_b32 v137, v13
    v_add_f32 v136, v136, v12
    v_add_f32 v137, v137, v13
    v_cvt_pk_bf16_f32 v138, v136, v137
    v_mov_b32 v139, s71
    v_lshlrev_b32 v10, 3, v1
    s_lshl_b32 s72, s68, 8
    s_add_u32 s72, s72, 0x1500
    s_mov_b32 exec_hi, 0
    buffer_store_dwordx2 v[138:139], v10, s[60:63], s72 offen offset:0 sc1
    s_mov_b64 exec, -1
L_exit7:
    s_waitcnt vmcnt(0)
L_end:
    s_endpgm
.set CODE_BYTES, L_end - adaLN_cond__sliding_local_dilated__dense_activation_silu__prompt_kernel - 16
.section .rodata,"a"
.p2align 6
.amdhsa_kernel adaLN_cond__sliding_local_dilated__dense_activation_silu__prompt_kernel
  .amdhsa_next_free_vgpr 256
  .amdhsa_next_free_sgpr 102
  .amdhsa_accum_offset 256
  .amdhsa_group_segment_fixed_size 0
  .amdhsa_kernarg_size 88
  .amdhsa_user_sgpr_count 2
  .amdhsa_user_sgpr_kernarg_segment_ptr 1
  .amdhsa_system_sgpr_workgroup_id_x 1
  .amdhsa_float_denorm_mode_32 3
  .amdhsa_float_denorm_mode_16_64 3
.end_amdhsa_kernel
```
